```python
import torch

def _softmax(x, axis=-1):
    return torch.softmax(x, dim=axis)
def _gelu(x):
    return torch.nn.functional.gelu(x, approximate="tanh")
def _silu(x):
    return torch.nn.functional.silu(x)
def _sigmoid(x):
    return torch.sigmoid(x)
def _layernorm(x, axis=-1, eps=1e-5):
    m = x.mean(dim=axis, keepdim=True)
    v = x.var(dim=axis, keepdim=True, unbiased=False)
    return (x - m) / torch.sqrt(v + eps)
def _scatter_add(tgt, idx, src, axis=0):
    return tgt.clone().index_add_(axis, idx, src)
def _segment_sum(src, seg, n):
    out = torch.zeros((n,) + src.shape[1:], dtype=src.dtype)
    return out.index_add_(0, seg, src)
def _pad(x, pw):
    flat = tuple(v for pair in reversed(pw) for v in pair)
    return torch.nn.functional.pad(x, flat)

kernel_name = 'standalone__mha_block_cached__near_ridge'

def setup_inputs():

    _w = (lambda a: (lambda t: t.to(torch.bfloat16) if t.is_floating_point() else t)(torch.as_tensor(a)))
    B, Sq, D = 8, 192, 576
    H, Sk, Dh = 32, 2048, 128
    return {
        "x": _w((lambda *s: torch.randn(*s, dtype=torch.bfloat16) * 0.8)(B, Sq, D)),
        "k_cache": _w((lambda *s: torch.randn(*s, dtype=torch.bfloat16) * 0.8)(B, H, Sk, Dh)),
        "v_cache": _w((lambda *s: torch.randn(*s, dtype=torch.bfloat16) * 0.05)(B, H, Sk, Dh)),
        "wq": _w((lambda *s: torch.randn(*s, dtype=torch.bfloat16) * 0.8)(D, H * Dh) * (D ** -0.5)),
        "wo": _w((lambda *s: torch.randn(*s, dtype=torch.bfloat16) * 0.05)(H * Dh, D) * ((H * Dh) ** -0.5)),
    }

def reference(x, k_cache, v_cache, wq, wo):
    B, Sq, D = x.shape
    H, Dh = 32, 128
    q = (lambda x, *d: x.permute(*d))((x @ wq).reshape(B, Sq, H, Dh), 0, 2, 1, 3)
    scores = torch.einsum("bhqd,bhkd->bhqk", q, k_cache) * (Dh ** -0.5)
    p = _softmax(scores, axis=-1)
    o = torch.einsum("bhqk,bhkd->bhqd", p, v_cache)
    return (lambda x, *d: x.permute(*d))(o, 0, 2, 1, 3).reshape(B, Sq, H * Dh) @ wo
```

```asm
; @launch grid=(256,1,1) block=(256,1,1) lds=163840
.amdgcn_target "amdgcn-amd-amdhsa--gfx950"
.text
.globl standalone__mha_block_cached__near_ridge_kernel
.p2align 8
.type standalone__mha_block_cached__near_ridge_kernel,@function
standalone__mha_block_cached__near_ridge_kernel:
s_cmp_ge_u32 s2, 256
s_cbranch_scc1 L_end
s_load_dwordx16 s[4:19], s[0:1], 0
v_and_b32 v1, 63, v0
v_lshrrev_b32 v0, 6, v0
s_and_b32 s48, s2, 3
s_lshl_b32 s48, s48, 3
s_bfe_u32 s49, s2, 0x30003
v_readfirstlane_b32 s3, v0
s_add_u32 s48, s48, s49
s_bfe_u32 s49, s2, 0x10002
s_lshl_b32 s49, s49, 2
s_lshr_b32 s50, s2, 6
s_add_u32 s49, s49, s50
v_lshrrev_b32 v244, 3, v1
v_and_b32 v245, 7, v1
s_mul_i32 s54, s3, 55296
v_lshrrev_b32 v246, 1, v244
v_xor_b32 v245, v245, v246
v_mul_u32_u24 v24, 1152, v244
v_lshl_add_u32 v24, v245, 4, v24
v_add_u32 v24, s54, v24
v_xor_b32 v246, 64, v24
v_add_u32 v25, 8192, v246
v_add_u32 v26, 16384, v24
v_add_u32 v27, 24576, v246
v_add_u32 v28, 36864, v24
v_add_u32 v29, 45056, v246
v_lshrrev_b32 v244, 4, v1
v_and_b32 v245, 15, v1
v_lshlrev_b32 v246, 2, v244
v_xor_b32 v246, v246, v245
v_lshlrev_b32 v246, 4, v246
v_lshl_add_u32 v30, v244, 13, v246
s_lshl_b32 s54, s3, 17
v_add_u32 v30, s54, v30
s_mul_i32 s70, s3, 6144
s_add_u32 s70, s70, 49152
s_lshl_b32 s71, s3, 12
s_lshl_b32 s54, s49, 1
s_add_u32 s54, s54, s48
s_and_b32 s54, s54, 7
s_lshl_b32 s68, s54, 7
s_lshl_b32 s69, s54, 19
s_mul_i32 s54, s49, 221184
s_lshl_b32 s55, s48, 8
s_mov_b32 s30, 221184
s_mov_b32 s31, 0x20000
s_sub_u32 s34, 4718592, s55
s_mov_b32 s35, 0x20000
s_waitcnt lgkmcnt(0)
s_add_u32 s28, s4, s54
s_addc_u32 s29, s5, 0
s_add_u32 s32, s10, s55
s_addc_u32 s33, s11, 0
s_add_u32 m0, s71, 16384
s_nop 0
buffer_load_dwordx4 v30, s[32:35], s69 offen offset:0 lds
s_add_u32 s55, s69, 31744
buffer_load_dwordx4 v30, s[32:35], s55 offen offset:1024 lds
s_add_u32 s55, s69, 63488
buffer_load_dwordx4 v30, s[32:35], s55 offen offset:2048 lds
s_add_u32 s55, s69, 95232
buffer_load_dwordx4 v30, s[32:35], s55 offen offset:3072 lds
s_add_u32 m0, s70, 0
s_nop 0
buffer_load_dwordx4 v24, s[28:31], s68 offen offset:0 lds
buffer_load_dwordx4 v25, s[28:31], s68 offen offset:1024 lds
buffer_load_dwordx4 v26, s[28:31], s68 offen offset:2048 lds
buffer_load_dwordx4 v27, s[28:31], s68 offen offset:3072 lds
s_add_u32 m0, s70, 4096
s_nop 0
buffer_load_dwordx4 v28, s[28:31], s68 offen offset:0 lds
buffer_load_dwordx4 v29, s[28:31], s68 offen offset:1024 lds
s_and_b32 s50, s3, 1
s_lshr_b32 s51, s3, 1
s_lshl_b32 s52, s50, 12
s_lshr_b32 s79, s2, 3
s_mul_i32 s79, s79, 5
s_and_b32 s54, s2, 7
s_mul_i32 s54, s54, 3
s_add_u32 s79, s79, s54
s_and_b32 s79, s79, 31
s_lshl_b32 s54, s49, 5
s_add_u32 s54, s54, s48
s_lshl_b32 s54, s54, 19
s_add_u32 s20, s6, s54
s_addc_u32 s21, s7, 0
s_mov_b32 s22, 524288
s_mov_b32 s23, 0x20000
s_add_u32 s24, s8, s54
s_addc_u32 s25, s9, 0
s_mov_b32 s26, 524288
s_mov_b32 s27, 0x20000
v_lshrrev_b32 v240, 4, v1
v_and_b32 v241, 15, v1
v_bfe_u32 v242, v1, 2, 2
v_and_b32 v243, 3, v1
v_lshrrev_b32 v247, 5, v1
v_and_b32 v248, 31, v1
v_bfe_u32 v244, v248, 1, 3
v_xor_b32 v244, v244, v247
v_lshlrev_b32 v244, 4, v244
v_lshl_add_u32 v244, v248, 7, v244
s_mul_i32 s54, s51, 12288
s_add_u32 s54, s54, 49152
v_add_u32 v32, s54, v244
v_xor_b32 v33, 32, v32
v_xor_b32 v34, 64, v32
v_xor_b32 v35, 96, v32
v_lshl_add_u32 v244, v247, 3, v242
v_lshlrev_b32 v244, 8, v244
v_lshl_add_u32 v244, v242, 6, v244
v_and_b32 v245, 1, v240
v_lshl_add_u32 v244, v245, 5, v244
v_lshl_add_u32 v244, v243, 3, v244
s_lshl_b32 s54, s50, 7
v_xor_b32 v36, s54, v244
v_xor_b32 v37, 64, v36
v_add_u32 v38, 122880, v36
v_add_u32 v39, 122880, v37
v_lshlrev_b32 v244, 1, v240
v_xor_b32 v244, v244, v241
v_lshlrev_b32 v244, 4, v244
v_lshl_add_u32 v244, v240, 8, v244
s_lshl_b32 s54, s51, 18
s_add_u32 s54, s54, s52
v_add_u32 v2, s54, v244
v_xor_b32 v3, 128, v2
v_and_b32 v244, 7, v1
v_lshlrev_b32 v244, 1, v244
v_xor_b32 v244, v244, v240
v_lshlrev_b32 v244, 4, v244
v_lshl_add_u32 v244, v241, 8, v244
s_lshl_b32 s54, s50, 13
v_add_u32 v4, s54, v244
v_xor_b32 v5, 64, v4
v_xor_b32 v6, 128, v4
v_xor_b32 v7, 192, v4
v_lshl_add_u32 v244, v240, 2, v242
v_and_b32 v245, 7, v244
v_lshlrev_b32 v245, 5, v245
v_lshl_add_u32 v245, v244, 8, v245
v_lshl_add_u32 v245, v243, 3, v245
s_add_u32 s54, s54, 16384
v_add_u32 v245, s54, v245
s_lshl_b32 s54, s50, 7
v_xor_b32 v8, s54, v245
v_xor_b32 v9, 32, v8
v_xor_b32 v10, 64, v8
v_xor_b32 v11, 96, v8
v_xor_b32 v12, 128, v8
v_xor_b32 v13, 160, v8
v_xor_b32 v14, 192, v8
v_xor_b32 v15, 224, v8
s_mul_i32 s55, s51, 122880
s_add_u32 s55, s55, 16384
s_mul_i32 s56, s51, 24576
s_add_u32 s56, s56, 131072
v_and_b32 v244, 15, v248
v_lshlrev_b32 v244, 4, v244
v_lshl_add_u32 v244, v248, 8, v244
v_lshl_add_u32 v244, v247, 3, v244
v_xor_b32 v244, s54, v244
v_add_u32 v40, s55, v244
v_add_u32 v112, s56, v244
v_xor_b32 v245, 16, v244
v_add_u32 v41, s55, v245
v_add_u32 v113, s56, v245
v_xor_b32 v245, 32, v244
v_add_u32 v42, s55, v245
v_add_u32 v114, s56, v245
v_xor_b32 v245, 48, v244
v_add_u32 v43, s55, v245
v_add_u32 v115, s56, v245
v_xor_b32 v245, 64, v244
v_add_u32 v44, s55, v245
v_add_u32 v116, s56, v245
v_xor_b32 v245, 80, v244
v_add_u32 v45, s55, v245
v_add_u32 v117, s56, v245
v_xor_b32 v245, 96, v244
v_add_u32 v46, s55, v245
v_add_u32 v118, s56, v245
v_xor_b32 v245, 112, v244
v_add_u32 v47, s55, v245
v_add_u32 v119, s56, v245
v_xor_b32 v244, v240, v241
v_lshlrev_b32 v244, 4, v244
v_lshl_add_u32 v244, v241, 8, v244
v_xor_b32 v245, 64, v244
v_xor_b32 v246, 128, v244
v_xor_b32 v247, 192, v244
s_add_u32 s57, s55, 0
s_add_u32 s58, s55, 12288
s_cmp_eq_u32 s50, 0
s_cselect_b32 s57, s57, s58
v_add_u32 v88, s57, v244
v_add_u32 v89, s57, v245
v_add_u32 v90, s57, v246
v_add_u32 v91, s57, v247
s_add_u32 s57, s55, 4096
s_add_u32 s58, s56, 0
s_cmp_eq_u32 s50, 0
s_cselect_b32 s57, s57, s58
v_add_u32 v92, s57, v244
v_add_u32 v93, s57, v245
v_add_u32 v94, s57, v246
v_add_u32 v95, s57, v247
s_add_u32 s57, s55, 8192
s_add_u32 s58, s56, 4096
s_cmp_eq_u32 s50, 0
s_cselect_b32 s57, s57, s58
v_add_u32 v96, s57, v244
v_add_u32 v97, s57, v245
v_add_u32 v98, s57, v246
v_add_u32 v99, s57, v247
s_add_u32 s57, s55, 12288
s_add_u32 s58, s55, 0
s_cmp_eq_u32 s50, 0
s_cselect_b32 s57, s57, s58
v_add_u32 v100, s57, v244
v_add_u32 v101, s57, v245
v_add_u32 v102, s57, v246
v_add_u32 v103, s57, v247
s_add_u32 s57, s56, 0
s_add_u32 s58, s55, 4096
s_cmp_eq_u32 s50, 0
s_cselect_b32 s57, s57, s58
v_add_u32 v104, s57, v244
v_add_u32 v105, s57, v245
v_add_u32 v106, s57, v246
v_add_u32 v107, s57, v247
s_add_u32 s57, s56, 4096
s_add_u32 s58, s55, 8192
s_cmp_eq_u32 s50, 0
s_cselect_b32 s57, s57, s58
v_add_u32 v108, s57, v244
v_add_u32 v109, s57, v245
v_add_u32 v110, s57, v246
v_add_u32 v111, s57, v247
v_mov_b32 v120, 0
v_mov_b32 v121, 0
v_mov_b32 v122, 0
v_mov_b32 v123, 0
v_mov_b32 v124, 0
v_mov_b32 v125, 0
v_mov_b32 v126, 0
v_mov_b32 v127, 0
v_mov_b32 v128, 0
v_mov_b32 v129, 0
v_mov_b32 v130, 0
v_mov_b32 v131, 0
v_mov_b32 v132, 0
v_mov_b32 v133, 0
v_mov_b32 v134, 0
v_mov_b32 v135, 0
v_mov_b32 v136, 0
v_mov_b32 v137, 0
v_mov_b32 v138, 0
v_mov_b32 v139, 0
v_mov_b32 v140, 0
v_mov_b32 v141, 0
v_mov_b32 v142, 0
v_mov_b32 v143, 0
s_mov_b32 s65, 0
s_mov_b32 s66, 0x3e0293ee
s_mov_b32 s67, 0x3e0293ee
s_add_u32 m0, s71, 122880
s_add_u32 s69, s69, 524288
s_cmp_eq_u32 s69, 4718592
s_cselect_b32 s69, 0, s69
buffer_load_dwordx4 v30, s[32:35], s69 offen offset:0 lds
s_add_u32 s55, s69, 31744
buffer_load_dwordx4 v30, s[32:35], s55 offen offset:1024 lds
s_add_u32 s55, s69, 63488
buffer_load_dwordx4 v30, s[32:35], s55 offen offset:2048 lds
s_add_u32 s55, s69, 95232
buffer_load_dwordx4 v30, s[32:35], s55 offen offset:3072 lds
s_add_u32 m0, s70, 24576
s_add_u32 s68, s68, 128
s_cmp_eq_u32 s68, 1152
s_cselect_b32 s68, 0, s68
buffer_load_dwordx4 v24, s[28:31], s68 offen offset:0 lds
buffer_load_dwordx4 v25, s[28:31], s68 offen offset:1024 lds
buffer_load_dwordx4 v26, s[28:31], s68 offen offset:2048 lds
buffer_load_dwordx4 v27, s[28:31], s68 offen offset:3072 lds
s_add_u32 m0, s70, 28672
s_nop 0
buffer_load_dwordx4 v28, s[28:31], s68 offen offset:0 lds
buffer_load_dwordx4 v29, s[28:31], s68 offen offset:1024 lds
s_waitcnt vmcnt(10)
s_barrier
ds_read_b64_tr_b16 v[48:49], v36 offset:16384
ds_read_b64_tr_b16 v[50:51], v36 offset:17408
ds_read_b128 v[64:67], v32 offset:0
ds_read_b64_tr_b16 v[52:53], v37 offset:16384
ds_read_b64_tr_b16 v[54:55], v37 offset:17408
ds_read_b128 v[68:71], v32 offset:4096
ds_read_b128 v[72:75], v32 offset:8192
s_waitcnt lgkmcnt(5)
s_waitcnt lgkmcnt(4)
v_mfma_f32_32x32x16_bf16 v[144:159], v[48:51], v[64:67], 0
ds_read_b64_tr_b16 v[56:57], v36 offset:20480
ds_read_b64_tr_b16 v[58:59], v36 offset:21504
s_add_u32 m0, s71, 139264
s_add_u32 s69, s69, 524288
s_cmp_eq_u32 s69, 4718592
s_cselect_b32 s69, 0, s69
buffer_load_dwordx4 v30, s[32:35], s69 offen offset:0 lds
s_waitcnt lgkmcnt(4)
v_mfma_f32_32x32x16_bf16 v[160:175], v[52:55], v[64:67], 0
ds_read_b128 v[76:79], v33 offset:0
ds_read_b64_tr_b16 v[60:61], v37 offset:20480
s_add_u32 s55, s69, 31744
buffer_load_dwordx4 v30, s[32:35], s55 offen offset:1024 lds
s_waitcnt lgkmcnt(5)
v_mfma_f32_32x32x16_bf16 v[176:191], v[48:51], v[68:71], 0
ds_read_b64_tr_b16 v[62:63], v37 offset:21504
ds_read_b128 v[80:83], v33 offset:4096
v_mfma_f32_32x32x16_bf16 v[192:207], v[52:55], v[68:71], 0
ds_read_b128 v[84:87], v33 offset:8192
s_add_u32 s55, s69, 63488
buffer_load_dwordx4 v30, s[32:35], s55 offen offset:2048 lds
s_waitcnt lgkmcnt(7)
v_mfma_f32_32x32x16_bf16 v[208:223], v[48:51], v[72:75], 0
v_mfma_f32_32x32x16_bf16 v[224:239], v[52:55], v[72:75], 0
s_add_u32 s55, s69, 95232
buffer_load_dwordx4 v30, s[32:35], s55 offen offset:3072 lds
s_waitcnt lgkmcnt(5)
s_waitcnt lgkmcnt(4)
v_mfma_f32_32x32x16_bf16 v[144:159], v[56:59], v[76:79], v[144:159]
ds_read_b64_tr_b16 v[48:49], v36 offset:24576
ds_read_b64_tr_b16 v[50:51], v36 offset:25600
s_waitcnt lgkmcnt(4)
v_mfma_f32_32x32x16_bf16 v[160:175], v[60:63], v[76:79], v[160:175]
ds_read_b128 v[64:67], v34 offset:0
ds_read_b64_tr_b16 v[52:53], v37 offset:24576
s_add_u32 m0, s70, 49152
s_add_u32 s68, s68, 128
s_cmp_eq_u32 s68, 1152
s_cselect_b32 s68, 0, s68
buffer_load_dwordx4 v24, s[28:31], s68 offen offset:0 lds
s_waitcnt lgkmcnt(5)
v_mfma_f32_32x32x16_bf16 v[176:191], v[56:59], v[80:83], v[176:191]
ds_read_b64_tr_b16 v[54:55], v37 offset:25600
ds_read_b128 v[68:71], v34 offset:4096
v_mfma_f32_32x32x16_bf16 v[192:207], v[60:63], v[80:83], v[192:207]
ds_read_b128 v[72:75], v34 offset:8192
buffer_load_dwordx4 v25, s[28:31], s68 offen offset:1024 lds
s_waitcnt lgkmcnt(7)
v_mfma_f32_32x32x16_bf16 v[208:223], v[56:59], v[84:87], v[208:223]
v_mfma_f32_32x32x16_bf16 v[224:239], v[60:63], v[84:87], v[224:239]
buffer_load_dwordx4 v26, s[28:31], s68 offen offset:2048 lds
s_waitcnt lgkmcnt(5)
s_waitcnt lgkmcnt(4)
v_mfma_f32_32x32x16_bf16 v[144:159], v[48:51], v[64:67], v[144:159]
ds_read_b64_tr_b16 v[56:57], v36 offset:28672
ds_read_b64_tr_b16 v[58:59], v36 offset:29696
s_waitcnt lgkmcnt(4)
v_mfma_f32_32x32x16_bf16 v[160:175], v[52:55], v[64:67], v[160:175]
ds_read_b128 v[76:79], v35 offset:0
ds_read_b64_tr_b16 v[60:61], v37 offset:28672
buffer_load_dwordx4 v27, s[28:31], s68 offen offset:3072 lds
s_waitcnt lgkmcnt(5)
v_mfma_f32_32x32x16_bf16 v[176:191], v[48:51], v[68:71], v[176:191]
ds_read_b64_tr_b16 v[62:63], v37 offset:29696
ds_read_b128 v[80:83], v35 offset:4096
v_mfma_f32_32x32x16_bf16 v[192:207], v[52:55], v[68:71], v[192:207]
ds_read_b128 v[84:87], v35 offset:8192
s_add_u32 m0, s70, 53248
s_nop 0
buffer_load_dwordx4 v28, s[28:31], s68 offen offset:0 lds
s_waitcnt lgkmcnt(7)
v_mfma_f32_32x32x16_bf16 v[208:223], v[48:51], v[72:75], v[208:223]
v_mfma_f32_32x32x16_bf16 v[224:239], v[52:55], v[72:75], v[224:239]
buffer_load_dwordx4 v29, s[28:31], s68 offen offset:1024 lds
s_waitcnt lgkmcnt(5)
s_waitcnt lgkmcnt(4)
v_mfma_f32_32x32x16_bf16 v[144:159], v[56:59], v[76:79], v[144:159]
s_waitcnt vmcnt(10) lgkmcnt(0)
s_barrier
ds_read_b64_tr_b16 v[48:49], v38 offset:0
ds_read_b64_tr_b16 v[50:51], v38 offset:1024
s_add_u32 m0, s71, 16384
s_add_u32 s69, s69, 524288
s_cmp_eq_u32 s69, 4718592
s_cselect_b32 s69, 0, s69
buffer_load_dwordx4 v30, s[32:35], s69 offen offset:0 lds
v_mfma_f32_32x32x16_bf16 v[160:175], v[60:63], v[76:79], v[160:175]
ds_read_b128 v[64:67], v32 offset:24576
ds_read_b64_tr_b16 v[52:53], v39 offset:0
v_mfma_f32_32x32x16_bf16 v[176:191], v[56:59], v[80:83], v[176:191]
ds_read_b64_tr_b16 v[54:55], v39 offset:1024
ds_read_b128 v[68:71], v32 offset:28672
s_add_u32 s55, s69, 31744
buffer_load_dwordx4 v30, s[32:35], s55 offen offset:1024 lds
v_mfma_f32_32x32x16_bf16 v[192:207], v[60:63], v[80:83], v[192:207]
ds_read_b128 v[72:75], v32 offset:32768
v_mfma_f32_32x32x16_bf16 v[208:223], v[56:59], v[84:87], v[208:223]
s_add_u32 s55, s69, 63488
buffer_load_dwordx4 v30, s[32:35], s55 offen offset:2048 lds
v_mfma_f32_32x32x16_bf16 v[224:239], v[60:63], v[84:87], v[224:239]
s_waitcnt lgkmcnt(5)
s_waitcnt lgkmcnt(4)
v_mfma_f32_32x32x16_bf16 v[144:159], v[48:51], v[64:67], v[144:159]
ds_read_b64_tr_b16 v[56:57], v38 offset:4096
ds_read_b64_tr_b16 v[58:59], v38 offset:5120
s_add_u32 s55, s69, 95232
buffer_load_dwordx4 v30, s[32:35], s55 offen offset:3072 lds
s_waitcnt lgkmcnt(4)
v_mfma_f32_32x32x16_bf16 v[160:175], v[52:55], v[64:67], v[160:175]
ds_read_b128 v[76:79], v33 offset:24576
ds_read_b64_tr_b16 v[60:61], v39 offset:4096
s_waitcnt lgkmcnt(5)
v_mfma_f32_32x32x16_bf16 v[176:191], v[48:51], v[68:71], v[176:191]
ds_read_b64_tr_b16 v[62:63], v39 offset:5120
ds_read_b128 v[80:83], v33 offset:28672
s_add_u32 m0, s70, 0
s_add_u32 s68, s68, 128
s_cmp_eq_u32 s68, 1152
s_cselect_b32 s68, 0, s68
buffer_load_dwordx4 v24, s[28:31], s68 offen offset:0 lds
v_mfma_f32_32x32x16_bf16 v[192:207], v[52:55], v[68:71], v[192:207]
ds_read_b128 v[84:87], v33 offset:32768
s_waitcnt lgkmcnt(7)
v_mfma_f32_32x32x16_bf16 v[208:223], v[48:51], v[72:75], v[208:223]
buffer_load_dwordx4 v25, s[28:31], s68 offen offset:1024 lds
v_mfma_f32_32x32x16_bf16 v[224:239], v[52:55], v[72:75], v[224:239]
s_waitcnt lgkmcnt(5)
s_waitcnt lgkmcnt(4)
v_mfma_f32_32x32x16_bf16 v[144:159], v[56:59], v[76:79], v[144:159]
ds_read_b64_tr_b16 v[48:49], v38 offset:8192
ds_read_b64_tr_b16 v[50:51], v38 offset:9216
buffer_load_dwordx4 v26, s[28:31], s68 offen offset:2048 lds
s_waitcnt lgkmcnt(4)
v_mfma_f32_32x32x16_bf16 v[160:175], v[60:63], v[76:79], v[160:175]
ds_read_b128 v[64:67], v34 offset:24576
ds_read_b64_tr_b16 v[52:53], v39 offset:8192
s_waitcnt lgkmcnt(5)
v_mfma_f32_32x32x16_bf16 v[176:191], v[56:59], v[80:83], v[176:191]
ds_read_b64_tr_b16 v[54:55], v39 offset:9216
ds_read_b128 v[68:71], v34 offset:28672
buffer_load_dwordx4 v27, s[28:31], s68 offen offset:3072 lds
v_mfma_f32_32x32x16_bf16 v[192:207], v[60:63], v[80:83], v[192:207]
ds_read_b128 v[72:75], v34 offset:32768
s_waitcnt lgkmcnt(7)
v_mfma_f32_32x32x16_bf16 v[208:223], v[56:59], v[84:87], v[208:223]
s_add_u32 m0, s70, 4096
s_nop 0
buffer_load_dwordx4 v28, s[28:31], s68 offen offset:0 lds
v_mfma_f32_32x32x16_bf16 v[224:239], v[60:63], v[84:87], v[224:239]
s_waitcnt lgkmcnt(5)
s_waitcnt lgkmcnt(4)
v_mfma_f32_32x32x16_bf16 v[144:159], v[48:51], v[64:67], v[144:159]
ds_read_b64_tr_b16 v[56:57], v38 offset:12288
ds_read_b64_tr_b16 v[58:59], v38 offset:13312
buffer_load_dwordx4 v29, s[28:31], s68 offen offset:1024 lds
s_waitcnt lgkmcnt(4)
v_mfma_f32_32x32x16_bf16 v[160:175], v[52:55], v[64:67], v[160:175]
ds_read_b128 v[76:79], v35 offset:24576
ds_read_b64_tr_b16 v[60:61], v39 offset:12288
s_waitcnt lgkmcnt(5)
v_mfma_f32_32x32x16_bf16 v[176:191], v[48:51], v[68:71], v[176:191]
ds_read_b64_tr_b16 v[62:63], v39 offset:13312
ds_read_b128 v[80:83], v35 offset:28672
v_mfma_f32_32x32x16_bf16 v[192:207], v[52:55], v[68:71], v[192:207]
ds_read_b128 v[84:87], v35 offset:32768
s_waitcnt lgkmcnt(7)
v_mfma_f32_32x32x16_bf16 v[208:223], v[48:51], v[72:75], v[208:223]
v_mfma_f32_32x32x16_bf16 v[224:239], v[52:55], v[72:75], v[224:239]
s_waitcnt lgkmcnt(5)
s_waitcnt lgkmcnt(4)
v_mfma_f32_32x32x16_bf16 v[144:159], v[56:59], v[76:79], v[144:159]
s_waitcnt vmcnt(10) lgkmcnt(0)
s_barrier
ds_read_b64_tr_b16 v[48:49], v38 offset:16384
ds_read_b64_tr_b16 v[50:51], v38 offset:17408
s_add_u32 m0, s71, 122880
s_add_u32 s69, s69, 524288
s_cmp_eq_u32 s69, 4718592
s_cselect_b32 s69, 0, s69
buffer_load_dwordx4 v30, s[32:35], s69 offen offset:0 lds
v_mfma_f32_32x32x16_bf16 v[160:175], v[60:63], v[76:79], v[160:175]
ds_read_b128 v[64:67], v32 offset:49152
ds_read_b64_tr_b16 v[52:53], v39 offset:16384
s_add_u32 s55, s69, 31744
buffer_load_dwordx4 v30, s[32:35], s55 offen offset:1024 lds
v_mfma_f32_32x32x16_bf16 v[176:191], v[56:59], v[80:83], v[176:191]
ds_read_b64_tr_b16 v[54:55], v39 offset:17408
ds_read_b128 v[68:71], v32 offset:53248
v_mfma_f32_32x32x16_bf16 v[192:207], v[60:63], v[80:83], v[192:207]
ds_read_b128 v[72:75], v32 offset:57344
s_add_u32 s55, s69, 63488
buffer_load_dwordx4 v30, s[32:35], s55 offen offset:2048 lds
v_mfma_f32_32x32x16_bf16 v[208:223], v[56:59], v[84:87], v[208:223]
v_mfma_f32_32x32x16_bf16 v[224:239], v[60:63], v[84:87], v[224:239]
s_add_u32 s55, s69, 95232
buffer_load_dwordx4 v30, s[32:35], s55 offen offset:3072 lds
s_waitcnt lgkmcnt(5)
s_waitcnt lgkmcnt(4)
v_mfma_f32_32x32x16_bf16 v[144:159], v[48:51], v[64:67], v[144:159]
ds_read_b64_tr_b16 v[56:57], v38 offset:20480
ds_read_b64_tr_b16 v[58:59], v38 offset:21504
s_waitcnt lgkmcnt(4)
v_mfma_f32_32x32x16_bf16 v[160:175], v[52:55], v[64:67], v[160:175]
ds_read_b128 v[76:79], v33 offset:49152
ds_read_b64_tr_b16 v[60:61], v39 offset:20480
s_add_u32 m0, s70, 24576
s_add_u32 s68, s68, 128
s_cmp_eq_u32 s68, 1152
s_cselect_b32 s68, 0, s68
buffer_load_dwordx4 v24, s[28:31], s68 offen offset:0 lds
s_waitcnt lgkmcnt(5)
v_mfma_f32_32x32x16_bf16 v[176:191], v[48:51], v[68:71], v[176:191]
ds_read_b64_tr_b16 v[62:63], v39 offset:21504
ds_read_b128 v[80:83], v33 offset:53248
buffer_load_dwordx4 v25, s[28:31], s68 offen offset:1024 lds
v_mfma_f32_32x32x16_bf16 v[192:207], v[52:55], v[68:71], v[192:207]
ds_read_b128 v[84:87], v33 offset:57344
s_waitcnt lgkmcnt(7)
v_mfma_f32_32x32x16_bf16 v[208:223], v[48:51], v[72:75], v[208:223]
buffer_load_dwordx4 v26, s[28:31], s68 offen offset:2048 lds
v_mfma_f32_32x32x16_bf16 v[224:239], v[52:55], v[72:75], v[224:239]
s_waitcnt lgkmcnt(5)
s_waitcnt lgkmcnt(4)
v_mfma_f32_32x32x16_bf16 v[144:159], v[56:59], v[76:79], v[144:159]
ds_read_b64_tr_b16 v[48:49], v38 offset:24576
ds_read_b64_tr_b16 v[50:51], v38 offset:25600
buffer_load_dwordx4 v27, s[28:31], s68 offen offset:3072 lds
s_waitcnt lgkmcnt(4)
v_mfma_f32_32x32x16_bf16 v[160:175], v[60:63], v[76:79], v[160:175]
ds_read_b128 v[64:67], v34 offset:49152
ds_read_b64_tr_b16 v[52:53], v39 offset:24576
s_waitcnt lgkmcnt(5)
v_mfma_f32_32x32x16_bf16 v[176:191], v[56:59], v[80:83], v[176:191]
ds_read_b64_tr_b16 v[54:55], v39 offset:25600
ds_read_b128 v[68:71], v34 offset:53248
s_add_u32 m0, s70, 28672
s_nop 0
buffer_load_dwordx4 v28, s[28:31], s68 offen offset:0 lds
v_mfma_f32_32x32x16_bf16 v[192:207], v[60:63], v[80:83], v[192:207]
ds_read_b128 v[72:75], v34 offset:57344
buffer_load_dwordx4 v29, s[28:31], s68 offen offset:1024 lds
s_waitcnt lgkmcnt(7)
v_mfma_f32_32x32x16_bf16 v[208:223], v[56:59], v[84:87], v[208:223]
v_mfma_f32_32x32x16_bf16 v[224:239], v[60:63], v[84:87], v[224:239]
s_add_u32 m0, s71, 0
s_add_u32 s55, s79, 0
s_and_b32 s55, s55, 31
s_lshl_b32 s55, s55, 13
buffer_load_dwordx4 v2, s[20:23], s55 offen offset:0 nt lds
s_waitcnt lgkmcnt(5)
s_waitcnt lgkmcnt(4)
v_mfma_f32_32x32x16_bf16 v[144:159], v[48:51], v[64:67], v[144:159]
ds_read_b64_tr_b16 v[56:57], v38 offset:28672
ds_read_b64_tr_b16 v[58:59], v38 offset:29696
s_waitcnt lgkmcnt(4)
v_mfma_f32_32x32x16_bf16 v[160:175], v[52:55], v[64:67], v[160:175]
ds_read_b128 v[76:79], v35 offset:49152
ds_read_b64_tr_b16 v[60:61], v39 offset:28672
buffer_load_dwordx4 v3, s[20:23], s55 offen offset:1024 nt lds
s_waitcnt lgkmcnt(5)
v_mfma_f32_32x32x16_bf16 v[176:191], v[48:51], v[68:71], v[176:191]
ds_read_b64_tr_b16 v[62:63], v39 offset:29696
ds_read_b128 v[80:83], v35 offset:53248
v_mfma_f32_32x32x16_bf16 v[192:207], v[52:55], v[68:71], v[192:207]
ds_read_b128 v[84:87], v35 offset:57344
buffer_load_dwordx4 v2, s[20:23], s55 offen offset:2048 nt lds
s_waitcnt lgkmcnt(7)
v_mfma_f32_32x32x16_bf16 v[208:223], v[48:51], v[72:75], v[208:223]
v_mfma_f32_32x32x16_bf16 v[224:239], v[52:55], v[72:75], v[224:239]
buffer_load_dwordx4 v3, s[20:23], s55 offen offset:3072 nt lds
s_waitcnt lgkmcnt(5)
s_waitcnt lgkmcnt(4)
v_mfma_f32_32x32x16_bf16 v[144:159], v[56:59], v[76:79], v[144:159]
s_waitcnt vmcnt(14) lgkmcnt(0)
s_barrier
ds_read_b64_tr_b16 v[48:49], v36 offset:16384
ds_read_b64_tr_b16 v[50:51], v36 offset:17408
s_add_u32 m0, s71, 139264
s_add_u32 s69, s69, 524288
s_cmp_eq_u32 s69, 4718592
s_cselect_b32 s69, 0, s69
buffer_load_dwordx4 v30, s[32:35], s69 offen offset:0 lds
v_mfma_f32_32x32x16_bf16 v[160:175], v[60:63], v[76:79], v[160:175]
ds_read_b128 v[64:67], v32 offset:0
ds_read_b64_tr_b16 v[52:53], v37 offset:16384
v_mfma_f32_32x32x16_bf16 v[176:191], v[56:59], v[80:83], v[176:191]
ds_read_b64_tr_b16 v[54:55], v37 offset:17408
ds_read_b128 v[68:71], v32 offset:4096
s_add_u32 s55, s69, 31744
buffer_load_dwordx4 v30, s[32:35], s55 offen offset:1024 lds
v_mfma_f32_32x32x16_bf16 v[192:207], v[60:63], v[80:83], v[192:207]
ds_read_b128 v[72:75], v32 offset:8192
v_mfma_f32_32x32x16_bf16 v[208:223], v[56:59], v[84:87], v[208:223]
s_add_u32 s55, s69, 63488
buffer_load_dwordx4 v30, s[32:35], s55 offen offset:2048 lds
v_mfma_f32_32x32x16_bf16 v[224:239], v[60:63], v[84:87], v[224:239]
s_waitcnt lgkmcnt(5)
s_waitcnt lgkmcnt(4)
v_mfma_f32_32x32x16_bf16 v[144:159], v[48:51], v[64:67], v[144:159]
ds_read_b64_tr_b16 v[56:57], v36 offset:20480
ds_read_b64_tr_b16 v[58:59], v36 offset:21504
s_add_u32 s55, s69, 95232
buffer_load_dwordx4 v30, s[32:35], s55 offen offset:3072 lds
s_waitcnt lgkmcnt(4)
v_mfma_f32_32x32x16_bf16 v[160:175], v[52:55], v[64:67], v[160:175]
ds_read_b128 v[76:79], v33 offset:0
ds_read_b64_tr_b16 v[60:61], v37 offset:20480
s_waitcnt lgkmcnt(5)
v_mfma_f32_32x32x16_bf16 v[176:191], v[48:51], v[68:71], v[176:191]
ds_read_b64_tr_b16 v[62:63], v37 offset:21504
ds_read_b128 v[80:83], v33 offset:4096
s_add_u32 m0, s70, 49152
s_add_u32 s68, s68, 128
s_cmp_eq_u32 s68, 1152
s_cselect_b32 s68, 0, s68
buffer_load_dwordx4 v24, s[28:31], s68 offen offset:0 lds
v_mfma_f32_32x32x16_bf16 v[192:207], v[52:55], v[68:71], v[192:207]
ds_read_b128 v[84:87], v33 offset:8192
s_waitcnt lgkmcnt(7)
v_mfma_f32_32x32x16_bf16 v[208:223], v[48:51], v[72:75], v[208:223]
buffer_load_dwordx4 v25, s[28:31], s68 offen offset:1024 lds
v_mfma_f32_32x32x16_bf16 v[224:239], v[52:55], v[72:75], v[224:239]
s_waitcnt lgkmcnt(5)
s_waitcnt lgkmcnt(4)
v_mfma_f32_32x32x16_bf16 v[144:159], v[56:59], v[76:79], v[144:159]
ds_read_b64_tr_b16 v[48:49], v36 offset:24576
ds_read_b64_tr_b16 v[50:51], v36 offset:25600
buffer_load_dwordx4 v26, s[28:31], s68 offen offset:2048 lds
s_waitcnt lgkmcnt(4)
v_mfma_f32_32x32x16_bf16 v[160:175], v[60:63], v[76:79], v[160:175]
ds_read_b128 v[64:67], v34 offset:0
ds_read_b64_tr_b16 v[52:53], v37 offset:24576
s_waitcnt lgkmcnt(5)
v_mfma_f32_32x32x16_bf16 v[176:191], v[56:59], v[80:83], v[176:191]
ds_read_b64_tr_b16 v[54:55], v37 offset:25600
ds_read_b128 v[68:71], v34 offset:4096
buffer_load_dwordx4 v27, s[28:31], s68 offen offset:3072 lds
v_mfma_f32_32x32x16_bf16 v[192:207], v[60:63], v[80:83], v[192:207]
ds_read_b128 v[72:75], v34 offset:8192
s_waitcnt lgkmcnt(7)
v_mfma_f32_32x32x16_bf16 v[208:223], v[56:59], v[84:87], v[208:223]
s_add_u32 m0, s70, 53248
s_nop 0
buffer_load_dwordx4 v28, s[28:31], s68 offen offset:0 lds
v_mfma_f32_32x32x16_bf16 v[224:239], v[60:63], v[84:87], v[224:239]
s_waitcnt lgkmcnt(5)
s_waitcnt lgkmcnt(4)
v_mfma_f32_32x32x16_bf16 v[144:159], v[48:51], v[64:67], v[144:159]
ds_read_b64_tr_b16 v[56:57], v36 offset:28672
ds_read_b64_tr_b16 v[58:59], v36 offset:29696
buffer_load_dwordx4 v29, s[28:31], s68 offen offset:1024 lds
s_waitcnt lgkmcnt(4)
v_mfma_f32_32x32x16_bf16 v[160:175], v[52:55], v[64:67], v[160:175]
ds_read_b128 v[76:79], v35 offset:0
ds_read_b64_tr_b16 v[60:61], v37 offset:28672
s_waitcnt lgkmcnt(5)
v_mfma_f32_32x32x16_bf16 v[176:191], v[48:51], v[68:71], v[176:191]
ds_read_b64_tr_b16 v[62:63], v37 offset:29696
ds_read_b128 v[80:83], v35 offset:4096
v_mfma_f32_32x32x16_bf16 v[192:207], v[52:55], v[68:71], v[192:207]
ds_read_b128 v[84:87], v35 offset:8192
s_waitcnt lgkmcnt(7)
v_mfma_f32_32x32x16_bf16 v[208:223], v[48:51], v[72:75], v[208:223]
v_mfma_f32_32x32x16_bf16 v[224:239], v[52:55], v[72:75], v[224:239]
s_waitcnt lgkmcnt(5)
s_waitcnt lgkmcnt(4)
v_mfma_f32_32x32x16_bf16 v[144:159], v[56:59], v[76:79], v[144:159]
s_waitcnt vmcnt(14) lgkmcnt(0)
s_barrier
ds_read_b64_tr_b16 v[48:49], v38 offset:0
ds_read_b64_tr_b16 v[50:51], v38 offset:1024
s_add_u32 m0, s71, 16384
s_add_u32 s69, s69, 524288
s_cmp_eq_u32 s69, 4718592
s_cselect_b32 s69, 0, s69
buffer_load_dwordx4 v30, s[32:35], s69 offen offset:0 lds
v_mfma_f32_32x32x16_bf16 v[160:175], v[60:63], v[76:79], v[160:175]
ds_read_b128 v[64:67], v32 offset:24576
ds_read_b64_tr_b16 v[52:53], v39 offset:0
v_mfma_f32_32x32x16_bf16 v[176:191], v[56:59], v[80:83], v[176:191]
ds_read_b64_tr_b16 v[54:55], v39 offset:1024
ds_read_b128 v[68:71], v32 offset:28672
s_add_u32 s55, s69, 31744
buffer_load_dwordx4 v30, s[32:35], s55 offen offset:1024 lds
v_mfma_f32_32x32x16_bf16 v[192:207], v[60:63], v[80:83], v[192:207]
ds_read_b128 v[72:75], v32 offset:32768
v_mfma_f32_32x32x16_bf16 v[208:223], v[56:59], v[84:87], v[208:223]
s_add_u32 s55, s69, 63488
buffer_load_dwordx4 v30, s[32:35], s55 offen offset:2048 lds
v_mfma_f32_32x32x16_bf16 v[224:239], v[60:63], v[84:87], v[224:239]
s_waitcnt lgkmcnt(5)
s_waitcnt lgkmcnt(4)
v_mfma_f32_32x32x16_bf16 v[144:159], v[48:51], v[64:67], v[144:159]
ds_read_b64_tr_b16 v[56:57], v38 offset:4096
ds_read_b64_tr_b16 v[58:59], v38 offset:5120
s_add_u32 s55, s69, 95232
buffer_load_dwordx4 v30, s[32:35], s55 offen offset:3072 lds
s_waitcnt lgkmcnt(4)
v_mfma_f32_32x32x16_bf16 v[160:175], v[52:55], v[64:67], v[160:175]
ds_read_b128 v[76:79], v33 offset:24576
ds_read_b64_tr_b16 v[60:61], v39 offset:4096
s_waitcnt lgkmcnt(5)
v_mfma_f32_32x32x16_bf16 v[176:191], v[48:51], v[68:71], v[176:191]
ds_read_b64_tr_b16 v[62:63], v39 offset:5120
ds_read_b128 v[80:83], v33 offset:28672
s_add_u32 m0, s70, 0
s_add_u32 s68, s68, 128
s_cmp_eq_u32 s68, 1152
s_cselect_b32 s68, 0, s68
buffer_load_dwordx4 v24, s[28:31], s68 offen offset:0 lds
v_mfma_f32_32x32x16_bf16 v[192:207], v[52:55], v[68:71], v[192:207]
ds_read_b128 v[84:87], v33 offset:32768
s_waitcnt lgkmcnt(7)
v_mfma_f32_32x32x16_bf16 v[208:223], v[48:51], v[72:75], v[208:223]
buffer_load_dwordx4 v25, s[28:31], s68 offen offset:1024 lds
v_mfma_f32_32x32x16_bf16 v[224:239], v[52:55], v[72:75], v[224:239]
s_waitcnt lgkmcnt(5)
s_waitcnt lgkmcnt(4)
v_mfma_f32_32x32x16_bf16 v[144:159], v[56:59], v[76:79], v[144:159]
ds_read_b64_tr_b16 v[48:49], v38 offset:8192
ds_read_b64_tr_b16 v[50:51], v38 offset:9216
buffer_load_dwordx4 v26, s[28:31], s68 offen offset:2048 lds
s_waitcnt lgkmcnt(4)
v_mfma_f32_32x32x16_bf16 v[160:175], v[60:63], v[76:79], v[160:175]
ds_read_b128 v[64:67], v34 offset:24576
ds_read_b64_tr_b16 v[52:53], v39 offset:8192
s_waitcnt lgkmcnt(5)
v_mfma_f32_32x32x16_bf16 v[176:191], v[56:59], v[80:83], v[176:191]
ds_read_b64_tr_b16 v[54:55], v39 offset:9216
ds_read_b128 v[68:71], v34 offset:28672
buffer_load_dwordx4 v27, s[28:31], s68 offen offset:3072 lds
v_mfma_f32_32x32x16_bf16 v[192:207], v[60:63], v[80:83], v[192:207]
ds_read_b128 v[72:75], v34 offset:32768
s_waitcnt lgkmcnt(7)
v_mfma_f32_32x32x16_bf16 v[208:223], v[56:59], v[84:87], v[208:223]
s_add_u32 m0, s70, 4096
s_nop 0
buffer_load_dwordx4 v28, s[28:31], s68 offen offset:0 lds
v_mfma_f32_32x32x16_bf16 v[224:239], v[60:63], v[84:87], v[224:239]
s_waitcnt lgkmcnt(5)
s_waitcnt lgkmcnt(4)
v_mfma_f32_32x32x16_bf16 v[144:159], v[48:51], v[64:67], v[144:159]
ds_read_b64_tr_b16 v[56:57], v38 offset:12288
ds_read_b64_tr_b16 v[58:59], v38 offset:13312
buffer_load_dwordx4 v29, s[28:31], s68 offen offset:1024 lds
s_waitcnt lgkmcnt(4)
v_mfma_f32_32x32x16_bf16 v[160:175], v[52:55], v[64:67], v[160:175]
ds_read_b128 v[76:79], v35 offset:24576
ds_read_b64_tr_b16 v[60:61], v39 offset:12288
s_waitcnt lgkmcnt(5)
v_mfma_f32_32x32x16_bf16 v[176:191], v[48:51], v[68:71], v[176:191]
ds_read_b64_tr_b16 v[62:63], v39 offset:13312
ds_read_b128 v[80:83], v35 offset:28672
v_mfma_f32_32x32x16_bf16 v[192:207], v[52:55], v[68:71], v[192:207]
ds_read_b128 v[84:87], v35 offset:32768
s_waitcnt lgkmcnt(7)
v_mfma_f32_32x32x16_bf16 v[208:223], v[48:51], v[72:75], v[208:223]
v_mfma_f32_32x32x16_bf16 v[224:239], v[52:55], v[72:75], v[224:239]
s_waitcnt lgkmcnt(5)
s_waitcnt lgkmcnt(4)
v_mfma_f32_32x32x16_bf16 v[144:159], v[56:59], v[76:79], v[144:159]
s_waitcnt vmcnt(10) lgkmcnt(0)
s_barrier
ds_read_b64_tr_b16 v[48:49], v38 offset:16384
ds_read_b64_tr_b16 v[50:51], v38 offset:17408
s_add_u32 m0, s71, 122880
s_add_u32 s69, s69, 524288
s_cmp_eq_u32 s69, 4718592
s_cselect_b32 s69, 0, s69
buffer_load_dwordx4 v30, s[32:35], s69 offen offset:0 lds
v_mfma_f32_32x32x16_bf16 v[160:175], v[60:63], v[76:79], v[160:175]
ds_read_b128 v[64:67], v32 offset:49152
ds_read_b64_tr_b16 v[52:53], v39 offset:16384
s_add_u32 s55, s69, 31744
buffer_load_dwordx4 v30, s[32:35], s55 offen offset:1024 lds
v_mfma_f32_32x32x16_bf16 v[176:191], v[56:59], v[80:83], v[176:191]
ds_read_b64_tr_b16 v[54:55], v39 offset:17408
ds_read_b128 v[68:71], v32 offset:53248
v_mfma_f32_32x32x16_bf16 v[192:207], v[60:63], v[80:83], v[192:207]
ds_read_b128 v[72:75], v32 offset:57344
s_add_u32 s55, s69, 63488
buffer_load_dwordx4 v30, s[32:35], s55 offen offset:2048 lds
v_mfma_f32_32x32x16_bf16 v[208:223], v[56:59], v[84:87], v[208:223]
v_mfma_f32_32x32x16_bf16 v[224:239], v[60:63], v[84:87], v[224:239]
s_add_u32 s55, s69, 95232
buffer_load_dwordx4 v30, s[32:35], s55 offen offset:3072 lds
s_waitcnt lgkmcnt(5)
s_waitcnt lgkmcnt(4)
v_mfma_f32_32x32x16_bf16 v[144:159], v[48:51], v[64:67], v[144:159]
ds_read_b64_tr_b16 v[56:57], v38 offset:20480
ds_read_b64_tr_b16 v[58:59], v38 offset:21504
s_waitcnt lgkmcnt(4)
v_mfma_f32_32x32x16_bf16 v[160:175], v[52:55], v[64:67], v[160:175]
ds_read_b128 v[76:79], v33 offset:49152
ds_read_b64_tr_b16 v[60:61], v39 offset:20480
s_add_u32 m0, s70, 24576
s_add_u32 s68, s68, 128
s_cmp_eq_u32 s68, 1152
s_cselect_b32 s68, 0, s68
buffer_load_dwordx4 v24, s[28:31], s68 offen offset:0 lds
s_waitcnt lgkmcnt(5)
v_mfma_f32_32x32x16_bf16 v[176:191], v[48:51], v[68:71], v[176:191]
ds_read_b64_tr_b16 v[62:63], v39 offset:21504
ds_read_b128 v[80:83], v33 offset:53248
buffer_load_dwordx4 v25, s[28:31], s68 offen offset:1024 lds
v_mfma_f32_32x32x16_bf16 v[192:207], v[52:55], v[68:71], v[192:207]
ds_read_b128 v[84:87], v33 offset:57344
s_waitcnt lgkmcnt(7)
v_mfma_f32_32x32x16_bf16 v[208:223], v[48:51], v[72:75], v[208:223]
buffer_load_dwordx4 v26, s[28:31], s68 offen offset:2048 lds
v_mfma_f32_32x32x16_bf16 v[224:239], v[52:55], v[72:75], v[224:239]
s_waitcnt lgkmcnt(5)
s_waitcnt lgkmcnt(4)
v_mfma_f32_32x32x16_bf16 v[144:159], v[56:59], v[76:79], v[144:159]
ds_read_b64_tr_b16 v[48:49], v38 offset:24576
ds_read_b64_tr_b16 v[50:51], v38 offset:25600
buffer_load_dwordx4 v27, s[28:31], s68 offen offset:3072 lds
s_waitcnt lgkmcnt(4)
v_mfma_f32_32x32x16_bf16 v[160:175], v[60:63], v[76:79], v[160:175]
ds_read_b128 v[64:67], v34 offset:49152
ds_read_b64_tr_b16 v[52:53], v39 offset:24576
s_waitcnt lgkmcnt(5)
v_mfma_f32_32x32x16_bf16 v[176:191], v[56:59], v[80:83], v[176:191]
ds_read_b64_tr_b16 v[54:55], v39 offset:25600
ds_read_b128 v[68:71], v34 offset:53248
s_add_u32 m0, s70, 28672
s_nop 0
buffer_load_dwordx4 v28, s[28:31], s68 offen offset:0 lds
v_mfma_f32_32x32x16_bf16 v[192:207], v[60:63], v[80:83], v[192:207]
ds_read_b128 v[72:75], v34 offset:57344
buffer_load_dwordx4 v29, s[28:31], s68 offen offset:1024 lds
s_waitcnt lgkmcnt(7)
v_mfma_f32_32x32x16_bf16 v[208:223], v[56:59], v[84:87], v[208:223]
v_mfma_f32_32x32x16_bf16 v[224:239], v[60:63], v[84:87], v[224:239]
s_add_u32 m0, s71, 32768
s_add_u32 s55, s79, 1
s_and_b32 s55, s55, 31
s_lshl_b32 s55, s55, 13
buffer_load_dwordx4 v2, s[20:23], s55 offen offset:0 nt lds
s_waitcnt lgkmcnt(5)
s_waitcnt lgkmcnt(4)
v_mfma_f32_32x32x16_bf16 v[144:159], v[48:51], v[64:67], v[144:159]
ds_read_b64_tr_b16 v[56:57], v38 offset:28672
ds_read_b64_tr_b16 v[58:59], v38 offset:29696
s_waitcnt lgkmcnt(4)
v_mfma_f32_32x32x16_bf16 v[160:175], v[52:55], v[64:67], v[160:175]
ds_read_b128 v[76:79], v35 offset:49152
ds_read_b64_tr_b16 v[60:61], v39 offset:28672
buffer_load_dwordx4 v3, s[20:23], s55 offen offset:1024 nt lds
s_waitcnt lgkmcnt(5)
v_mfma_f32_32x32x16_bf16 v[176:191], v[48:51], v[68:71], v[176:191]
ds_read_b64_tr_b16 v[62:63], v39 offset:29696
ds_read_b128 v[80:83], v35 offset:53248
v_mfma_f32_32x32x16_bf16 v[192:207], v[52:55], v[68:71], v[192:207]
ds_read_b128 v[84:87], v35 offset:57344
buffer_load_dwordx4 v2, s[20:23], s55 offen offset:2048 nt lds
s_waitcnt lgkmcnt(7)
v_mfma_f32_32x32x16_bf16 v[208:223], v[48:51], v[72:75], v[208:223]
v_mfma_f32_32x32x16_bf16 v[224:239], v[52:55], v[72:75], v[224:239]
buffer_load_dwordx4 v3, s[20:23], s55 offen offset:3072 nt lds
s_waitcnt lgkmcnt(5)
s_waitcnt lgkmcnt(4)
v_mfma_f32_32x32x16_bf16 v[144:159], v[56:59], v[76:79], v[144:159]
s_waitcnt vmcnt(14) lgkmcnt(0)
s_barrier
ds_read_b64_tr_b16 v[48:49], v36 offset:16384
ds_read_b64_tr_b16 v[50:51], v36 offset:17408
s_add_u32 m0, s71, 139264
s_add_u32 s69, s69, 524288
s_cmp_eq_u32 s69, 4718592
s_cselect_b32 s69, 0, s69
buffer_load_dwordx4 v30, s[32:35], s69 offen offset:0 lds
v_mfma_f32_32x32x16_bf16 v[160:175], v[60:63], v[76:79], v[160:175]
ds_read_b128 v[64:67], v32 offset:0
ds_read_b64_tr_b16 v[52:53], v37 offset:16384
v_mfma_f32_32x32x16_bf16 v[176:191], v[56:59], v[80:83], v[176:191]
ds_read_b64_tr_b16 v[54:55], v37 offset:17408
ds_read_b128 v[68:71], v32 offset:4096
s_add_u32 s55, s69, 31744
buffer_load_dwordx4 v30, s[32:35], s55 offen offset:1024 lds
v_mfma_f32_32x32x16_bf16 v[192:207], v[60:63], v[80:83], v[192:207]
ds_read_b128 v[72:75], v32 offset:8192
v_mfma_f32_32x32x16_bf16 v[208:223], v[56:59], v[84:87], v[208:223]
s_add_u32 s55, s69, 63488
buffer_load_dwordx4 v30, s[32:35], s55 offen offset:2048 lds
v_mfma_f32_32x32x16_bf16 v[224:239], v[60:63], v[84:87], v[224:239]
s_waitcnt lgkmcnt(5)
s_waitcnt lgkmcnt(4)
v_mfma_f32_32x32x16_bf16 v[144:159], v[48:51], v[64:67], v[144:159]
ds_read_b64_tr_b16 v[56:57], v36 offset:20480
ds_read_b64_tr_b16 v[58:59], v36 offset:21504
s_add_u32 s55, s69, 95232
buffer_load_dwordx4 v30, s[32:35], s55 offen offset:3072 lds
s_waitcnt lgkmcnt(4)
v_mfma_f32_32x32x16_bf16 v[160:175], v[52:55], v[64:67], v[160:175]
ds_read_b128 v[76:79], v33 offset:0
ds_read_b64_tr_b16 v[60:61], v37 offset:20480
s_waitcnt lgkmcnt(5)
v_mfma_f32_32x32x16_bf16 v[176:191], v[48:51], v[68:71], v[176:191]
ds_read_b64_tr_b16 v[62:63], v37 offset:21504
ds_read_b128 v[80:83], v33 offset:4096
s_add_u32 m0, s70, 49152
s_add_u32 s68, s68, 128
s_cmp_eq_u32 s68, 1152
s_cselect_b32 s68, 0, s68
buffer_load_dwordx4 v24, s[28:31], s68 offen offset:0 lds
v_mfma_f32_32x32x16_bf16 v[192:207], v[52:55], v[68:71], v[192:207]
ds_read_b128 v[84:87], v33 offset:8192
s_waitcnt lgkmcnt(7)
v_mfma_f32_32x32x16_bf16 v[208:223], v[48:51], v[72:75], v[208:223]
buffer_load_dwordx4 v25, s[28:31], s68 offen offset:1024 lds
v_mfma_f32_32x32x16_bf16 v[224:239], v[52:55], v[72:75], v[224:239]
s_waitcnt lgkmcnt(5)
s_waitcnt lgkmcnt(4)
v_mfma_f32_32x32x16_bf16 v[144:159], v[56:59], v[76:79], v[144:159]
ds_read_b64_tr_b16 v[48:49], v36 offset:24576
ds_read_b64_tr_b16 v[50:51], v36 offset:25600
buffer_load_dwordx4 v26, s[28:31], s68 offen offset:2048 lds
s_waitcnt lgkmcnt(4)
v_mfma_f32_32x32x16_bf16 v[160:175], v[60:63], v[76:79], v[160:175]
ds_read_b128 v[64:67], v34 offset:0
ds_read_b64_tr_b16 v[52:53], v37 offset:24576
s_waitcnt lgkmcnt(5)
v_mfma_f32_32x32x16_bf16 v[176:191], v[56:59], v[80:83], v[176:191]
ds_read_b64_tr_b16 v[54:55], v37 offset:25600
ds_read_b128 v[68:71], v34 offset:4096
buffer_load_dwordx4 v27, s[28:31], s68 offen offset:3072 lds
v_mfma_f32_32x32x16_bf16 v[192:207], v[60:63], v[80:83], v[192:207]
ds_read_b128 v[72:75], v34 offset:8192
s_waitcnt lgkmcnt(7)
v_mfma_f32_32x32x16_bf16 v[208:223], v[56:59], v[84:87], v[208:223]
s_add_u32 m0, s70, 53248
s_nop 0
buffer_load_dwordx4 v28, s[28:31], s68 offen offset:0 lds
v_mfma_f32_32x32x16_bf16 v[224:239], v[60:63], v[84:87], v[224:239]
s_waitcnt lgkmcnt(5)
s_waitcnt lgkmcnt(4)
v_mfma_f32_32x32x16_bf16 v[144:159], v[48:51], v[64:67], v[144:159]
ds_read_b64_tr_b16 v[56:57], v36 offset:28672
ds_read_b64_tr_b16 v[58:59], v36 offset:29696
buffer_load_dwordx4 v29, s[28:31], s68 offen offset:1024 lds
s_waitcnt lgkmcnt(4)
v_mfma_f32_32x32x16_bf16 v[160:175], v[52:55], v[64:67], v[160:175]
ds_read_b128 v[76:79], v35 offset:0
ds_read_b64_tr_b16 v[60:61], v37 offset:28672
s_waitcnt lgkmcnt(5)
v_mfma_f32_32x32x16_bf16 v[176:191], v[48:51], v[68:71], v[176:191]
ds_read_b64_tr_b16 v[62:63], v37 offset:29696
ds_read_b128 v[80:83], v35 offset:4096
v_mfma_f32_32x32x16_bf16 v[192:207], v[52:55], v[68:71], v[192:207]
ds_read_b128 v[84:87], v35 offset:8192
s_waitcnt lgkmcnt(7)
v_mfma_f32_32x32x16_bf16 v[208:223], v[48:51], v[72:75], v[208:223]
v_mfma_f32_32x32x16_bf16 v[224:239], v[52:55], v[72:75], v[224:239]
s_waitcnt lgkmcnt(5)
s_waitcnt lgkmcnt(4)
v_mfma_f32_32x32x16_bf16 v[144:159], v[56:59], v[76:79], v[144:159]
s_waitcnt vmcnt(14) lgkmcnt(0)
s_barrier
ds_read_b64_tr_b16 v[48:49], v38 offset:0
ds_read_b64_tr_b16 v[50:51], v38 offset:1024
s_add_u32 m0, s71, 49152
s_add_u32 s55, s79, 0
s_and_b32 s55, s55, 31
s_lshl_b32 s55, s55, 13
buffer_load_dwordx4 v2, s[24:27], s55 offen offset:0 nt lds
v_mfma_f32_32x32x16_bf16 v[160:175], v[60:63], v[76:79], v[160:175]
ds_read_b128 v[64:67], v32 offset:24576
ds_read_b64_tr_b16 v[52:53], v39 offset:0
v_mfma_f32_32x32x16_bf16 v[176:191], v[56:59], v[80:83], v[176:191]
ds_read_b64_tr_b16 v[54:55], v39 offset:1024
ds_read_b128 v[68:71], v32 offset:28672
buffer_load_dwordx4 v3, s[24:27], s55 offen offset:1024 nt lds
v_mfma_f32_32x32x16_bf16 v[192:207], v[60:63], v[80:83], v[192:207]
ds_read_b128 v[72:75], v32 offset:32768
v_mfma_f32_32x32x16_bf16 v[208:223], v[56:59], v[84:87], v[208:223]
buffer_load_dwordx4 v2, s[24:27], s55 offen offset:2048 nt lds
v_mfma_f32_32x32x16_bf16 v[224:239], v[60:63], v[84:87], v[224:239]
s_waitcnt lgkmcnt(5)
s_waitcnt lgkmcnt(4)
v_mfma_f32_32x32x16_bf16 v[144:159], v[48:51], v[64:67], v[144:159]
ds_read_b64_tr_b16 v[56:57], v38 offset:4096
ds_read_b64_tr_b16 v[58:59], v38 offset:5120
buffer_load_dwordx4 v3, s[24:27], s55 offen offset:3072 nt lds
s_waitcnt lgkmcnt(4)
v_mfma_f32_32x32x16_bf16 v[160:175], v[52:55], v[64:67], v[160:175]
ds_read_b128 v[76:79], v33 offset:24576
ds_read_b64_tr_b16 v[60:61], v39 offset:4096
s_waitcnt lgkmcnt(5)
v_mfma_f32_32x32x16_bf16 v[176:191], v[48:51], v[68:71], v[176:191]
ds_read_b64_tr_b16 v[62:63], v39 offset:5120
ds_read_b128 v[80:83], v33 offset:28672
v_mfma_f32_32x32x16_bf16 v[192:207], v[52:55], v[68:71], v[192:207]
ds_read_b128 v[84:87], v33 offset:32768
s_waitcnt lgkmcnt(7)
v_mfma_f32_32x32x16_bf16 v[208:223], v[48:51], v[72:75], v[208:223]
v_mfma_f32_32x32x16_bf16 v[224:239], v[52:55], v[72:75], v[224:239]
s_waitcnt lgkmcnt(5)
s_waitcnt lgkmcnt(4)
v_mfma_f32_32x32x16_bf16 v[144:159], v[56:59], v[76:79], v[144:159]
ds_read_b64_tr_b16 v[48:49], v38 offset:8192
ds_read_b64_tr_b16 v[50:51], v38 offset:9216
s_waitcnt lgkmcnt(4)
v_mfma_f32_32x32x16_bf16 v[160:175], v[60:63], v[76:79], v[160:175]
ds_read_b128 v[64:67], v34 offset:24576
ds_read_b64_tr_b16 v[52:53], v39 offset:8192
s_waitcnt lgkmcnt(5)
v_mfma_f32_32x32x16_bf16 v[176:191], v[56:59], v[80:83], v[176:191]
ds_read_b64_tr_b16 v[54:55], v39 offset:9216
ds_read_b128 v[68:71], v34 offset:28672
v_mfma_f32_32x32x16_bf16 v[192:207], v[60:63], v[80:83], v[192:207]
ds_read_b128 v[72:75], v34 offset:32768
s_waitcnt lgkmcnt(7)
v_mfma_f32_32x32x16_bf16 v[208:223], v[56:59], v[84:87], v[208:223]
v_mfma_f32_32x32x16_bf16 v[224:239], v[60:63], v[84:87], v[224:239]
s_waitcnt lgkmcnt(5)
s_waitcnt lgkmcnt(4)
v_mfma_f32_32x32x16_bf16 v[144:159], v[48:51], v[64:67], v[144:159]
ds_read_b64_tr_b16 v[56:57], v38 offset:12288
ds_read_b64_tr_b16 v[58:59], v38 offset:13312
s_waitcnt lgkmcnt(4)
v_mfma_f32_32x32x16_bf16 v[160:175], v[52:55], v[64:67], v[160:175]
ds_read_b128 v[76:79], v35 offset:24576
ds_read_b64_tr_b16 v[60:61], v39 offset:12288
s_waitcnt lgkmcnt(5)
v_mfma_f32_32x32x16_bf16 v[176:191], v[48:51], v[68:71], v[176:191]
ds_read_b64_tr_b16 v[62:63], v39 offset:13312
ds_read_b128 v[80:83], v35 offset:28672
v_mfma_f32_32x32x16_bf16 v[192:207], v[52:55], v[68:71], v[192:207]
ds_read_b128 v[84:87], v35 offset:32768
s_waitcnt lgkmcnt(7)
v_mfma_f32_32x32x16_bf16 v[208:223], v[48:51], v[72:75], v[208:223]
v_mfma_f32_32x32x16_bf16 v[224:239], v[52:55], v[72:75], v[224:239]
s_waitcnt lgkmcnt(5)
s_waitcnt lgkmcnt(4)
v_mfma_f32_32x32x16_bf16 v[144:159], v[56:59], v[76:79], v[144:159]
s_waitcnt vmcnt(4) lgkmcnt(0)
s_barrier
ds_read_b64_tr_b16 v[48:49], v38 offset:16384
ds_read_b64_tr_b16 v[50:51], v38 offset:17408
s_add_u32 m0, s71, 65536
s_add_u32 s55, s79, 2
s_and_b32 s55, s55, 31
s_lshl_b32 s55, s55, 13
buffer_load_dwordx4 v2, s[20:23], s55 offen offset:0 nt lds
v_mfma_f32_32x32x16_bf16 v[160:175], v[60:63], v[76:79], v[160:175]
ds_read_b128 v[64:67], v32 offset:49152
ds_read_b64_tr_b16 v[52:53], v39 offset:16384
v_mfma_f32_32x32x16_bf16 v[176:191], v[56:59], v[80:83], v[176:191]
ds_read_b64_tr_b16 v[54:55], v39 offset:17408
ds_read_b128 v[68:71], v32 offset:53248
buffer_load_dwordx4 v3, s[20:23], s55 offen offset:1024 nt lds
v_mfma_f32_32x32x16_bf16 v[192:207], v[60:63], v[80:83], v[192:207]
ds_read_b128 v[72:75], v32 offset:57344
v_mfma_f32_32x32x16_bf16 v[208:223], v[56:59], v[84:87], v[208:223]
buffer_load_dwordx4 v2, s[20:23], s55 offen offset:2048 nt lds
v_mfma_f32_32x32x16_bf16 v[224:239], v[60:63], v[84:87], v[224:239]
s_waitcnt lgkmcnt(5)
s_waitcnt lgkmcnt(4)
v_mfma_f32_32x32x16_bf16 v[144:159], v[48:51], v[64:67], v[144:159]
ds_read_b64_tr_b16 v[56:57], v38 offset:20480
ds_read_b64_tr_b16 v[58:59], v38 offset:21504
buffer_load_dwordx4 v3, s[20:23], s55 offen offset:3072 nt lds
s_waitcnt lgkmcnt(4)
v_mfma_f32_32x32x16_bf16 v[160:175], v[52:55], v[64:67], v[160:175]
ds_read_b128 v[76:79], v33 offset:49152
ds_read_b64_tr_b16 v[60:61], v39 offset:20480
s_waitcnt lgkmcnt(5)
v_mfma_f32_32x32x16_bf16 v[176:191], v[48:51], v[68:71], v[176:191]
ds_read_b64_tr_b16 v[62:63], v39 offset:21504
ds_read_b128 v[80:83], v33 offset:53248
s_add_u32 m0, s71, 81920
s_add_u32 s55, s79, 1
s_and_b32 s55, s55, 31
s_lshl_b32 s55, s55, 13
buffer_load_dwordx4 v2, s[24:27], s55 offen offset:0 nt lds
v_mfma_f32_32x32x16_bf16 v[192:207], v[52:55], v[68:71], v[192:207]
ds_read_b128 v[84:87], v33 offset:57344
s_waitcnt lgkmcnt(7)
v_mfma_f32_32x32x16_bf16 v[208:223], v[48:51], v[72:75], v[208:223]
buffer_load_dwordx4 v3, s[24:27], s55 offen offset:1024 nt lds
v_mfma_f32_32x32x16_bf16 v[224:239], v[52:55], v[72:75], v[224:239]
s_waitcnt lgkmcnt(5)
s_waitcnt lgkmcnt(4)
v_mfma_f32_32x32x16_bf16 v[144:159], v[56:59], v[76:79], v[144:159]
ds_read_b64_tr_b16 v[48:49], v38 offset:24576
ds_read_b64_tr_b16 v[50:51], v38 offset:25600
buffer_load_dwordx4 v2, s[24:27], s55 offen offset:2048 nt lds
s_waitcnt lgkmcnt(4)
v_mfma_f32_32x32x16_bf16 v[160:175], v[60:63], v[76:79], v[160:175]
ds_read_b128 v[64:67], v34 offset:49152
ds_read_b64_tr_b16 v[52:53], v39 offset:24576
s_waitcnt lgkmcnt(5)
v_mfma_f32_32x32x16_bf16 v[176:191], v[56:59], v[80:83], v[176:191]
ds_read_b64_tr_b16 v[54:55], v39 offset:25600
ds_read_b128 v[68:71], v34 offset:53248
buffer_load_dwordx4 v3, s[24:27], s55 offen offset:3072 nt lds
v_mfma_f32_32x32x16_bf16 v[192:207], v[60:63], v[80:83], v[192:207]
ds_read_b128 v[72:75], v34 offset:57344
s_waitcnt lgkmcnt(7)
v_mfma_f32_32x32x16_bf16 v[208:223], v[56:59], v[84:87], v[208:223]
v_mfma_f32_32x32x16_bf16 v[224:239], v[60:63], v[84:87], v[224:239]
s_waitcnt lgkmcnt(5)
s_waitcnt lgkmcnt(4)
v_mfma_f32_32x32x16_bf16 v[144:159], v[48:51], v[64:67], v[144:159]
ds_read_b64_tr_b16 v[56:57], v38 offset:28672
ds_read_b64_tr_b16 v[58:59], v38 offset:29696
s_waitcnt lgkmcnt(4)
v_mfma_f32_32x32x16_bf16 v[160:175], v[52:55], v[64:67], v[160:175]
ds_read_b128 v[76:79], v35 offset:49152
ds_read_b64_tr_b16 v[60:61], v39 offset:28672
s_waitcnt lgkmcnt(5)
v_mfma_f32_32x32x16_bf16 v[176:191], v[48:51], v[68:71], v[176:191]
ds_read_b64_tr_b16 v[62:63], v39 offset:29696
ds_read_b128 v[80:83], v35 offset:53248
v_mfma_f32_32x32x16_bf16 v[192:207], v[52:55], v[68:71], v[192:207]
ds_read_b128 v[84:87], v35 offset:57344
s_waitcnt lgkmcnt(7)
v_mfma_f32_32x32x16_bf16 v[208:223], v[48:51], v[72:75], v[208:223]
v_mfma_f32_32x32x16_bf16 v[224:239], v[52:55], v[72:75], v[224:239]
s_waitcnt lgkmcnt(5)
s_waitcnt lgkmcnt(4)
v_mfma_f32_32x32x16_bf16 v[144:159], v[56:59], v[76:79], v[144:159]
s_waitcnt lgkmcnt(0)
s_barrier
s_add_u32 m0, s71, 98304
s_add_u32 s55, s79, 3
s_and_b32 s55, s55, 31
s_lshl_b32 s55, s55, 13
buffer_load_dwordx4 v2, s[20:23], s55 offen offset:0 nt lds
v_mfma_f32_32x32x16_bf16 v[160:175], v[60:63], v[76:79], v[160:175]
buffer_load_dwordx4 v3, s[20:23], s55 offen offset:1024 nt lds
v_mov_b32 v16, 0
v_mov_b32 v17, 0
v_mov_b32 v18, 0
v_mov_b32 v19, 0
v_mov_b32 v20, 0
v_mov_b32 v21, 0
s_lshl_b32 s54, s3, 12
s_add_u32 s54, s54, 150528
v_lshlrev_b32 v23, 2, v1
v_add_u32 v23, s54, v23
v_mfma_f32_32x32x16_bf16 v[176:191], v[56:59], v[80:83], v[176:191]
v_pk_mul_f32 v[144:145], v[144:145], s[66:67]
v_pk_mul_f32 v[146:147], v[146:147], s[66:67]
v_pk_mul_f32 v[148:149], v[148:149], s[66:67]
v_pk_mul_f32 v[150:151], v[150:151], s[66:67]
v_pk_mul_f32 v[152:153], v[152:153], s[66:67]
v_pk_mul_f32 v[154:155], v[154:155], s[66:67]
v_pk_mul_f32 v[156:157], v[156:157], s[66:67]
v_pk_mul_f32 v[158:159], v[158:159], s[66:67]
v_cvt_pk_bf16_f32 v144, v144, v145
v_cvt_pk_bf16_f32 v145, v146, v147
v_cvt_pk_bf16_f32 v148, v148, v149
v_cvt_pk_bf16_f32 v149, v150, v151
v_cvt_pk_bf16_f32 v152, v152, v153
v_cvt_pk_bf16_f32 v153, v154, v155
v_cvt_pk_bf16_f32 v156, v156, v157
v_cvt_pk_bf16_f32 v157, v158, v159
ds_write_b64 v40, v[144:145] offset:0
ds_write_b64 v41, v[148:149] offset:0
ds_write_b64 v42, v[152:153] offset:0
ds_write_b64 v43, v[156:157] offset:0
v_mfma_f32_32x32x16_bf16 v[192:207], v[60:63], v[80:83], v[192:207]
v_pk_mul_f32 v[160:161], v[160:161], s[66:67]
v_pk_mul_f32 v[162:163], v[162:163], s[66:67]
v_pk_mul_f32 v[164:165], v[164:165], s[66:67]
v_pk_mul_f32 v[166:167], v[166:167], s[66:67]
v_pk_mul_f32 v[168:169], v[168:169], s[66:67]
v_pk_mul_f32 v[170:171], v[170:171], s[66:67]
v_pk_mul_f32 v[172:173], v[172:173], s[66:67]
v_pk_mul_f32 v[174:175], v[174:175], s[66:67]
v_cvt_pk_bf16_f32 v160, v160, v161
v_cvt_pk_bf16_f32 v161, v162, v163
v_cvt_pk_bf16_f32 v164, v164, v165
v_cvt_pk_bf16_f32 v165, v166, v167
v_cvt_pk_bf16_f32 v168, v168, v169
v_cvt_pk_bf16_f32 v169, v170, v171
v_cvt_pk_bf16_f32 v172, v172, v173
v_cvt_pk_bf16_f32 v173, v174, v175
ds_write_b64 v44, v[160:161] offset:0
ds_write_b64 v45, v[164:165] offset:0
ds_write_b64 v46, v[168:169] offset:0
ds_write_b64 v47, v[172:173] offset:0
v_mfma_f32_32x32x16_bf16 v[208:223], v[56:59], v[84:87], v[208:223]
v_pk_mul_f32 v[176:177], v[176:177], s[66:67]
v_pk_mul_f32 v[178:179], v[178:179], s[66:67]
v_pk_mul_f32 v[180:181], v[180:181], s[66:67]
v_pk_mul_f32 v[182:183], v[182:183], s[66:67]
v_pk_mul_f32 v[184:185], v[184:185], s[66:67]
v_pk_mul_f32 v[186:187], v[186:187], s[66:67]
v_pk_mul_f32 v[188:189], v[188:189], s[66:67]
v_pk_mul_f32 v[190:191], v[190:191], s[66:67]
v_cvt_pk_bf16_f32 v176, v176, v177
v_cvt_pk_bf16_f32 v177, v178, v179
v_cvt_pk_bf16_f32 v180, v180, v181
v_cvt_pk_bf16_f32 v181, v182, v183
v_cvt_pk_bf16_f32 v184, v184, v185
v_cvt_pk_bf16_f32 v185, v186, v187
v_cvt_pk_bf16_f32 v188, v188, v189
v_cvt_pk_bf16_f32 v189, v190, v191
ds_write_b64 v40, v[176:177] offset:8192
ds_write_b64 v41, v[180:181] offset:8192
ds_write_b64 v42, v[184:185] offset:8192
ds_write_b64 v43, v[188:189] offset:8192
v_mfma_f32_32x32x16_bf16 v[224:239], v[60:63], v[84:87], v[224:239]
v_pk_mul_f32 v[192:193], v[192:193], s[66:67]
v_pk_mul_f32 v[194:195], v[194:195], s[66:67]
v_pk_mul_f32 v[196:197], v[196:197], s[66:67]
v_pk_mul_f32 v[198:199], v[198:199], s[66:67]
v_pk_mul_f32 v[200:201], v[200:201], s[66:67]
v_pk_mul_f32 v[202:203], v[202:203], s[66:67]
v_pk_mul_f32 v[204:205], v[204:205], s[66:67]
v_pk_mul_f32 v[206:207], v[206:207], s[66:67]
v_cvt_pk_bf16_f32 v192, v192, v193
v_cvt_pk_bf16_f32 v193, v194, v195
v_cvt_pk_bf16_f32 v196, v196, v197
v_cvt_pk_bf16_f32 v197, v198, v199
v_cvt_pk_bf16_f32 v200, v200, v201
v_cvt_pk_bf16_f32 v201, v202, v203
v_cvt_pk_bf16_f32 v204, v204, v205
v_cvt_pk_bf16_f32 v205, v206, v207
ds_write_b64 v44, v[192:193] offset:8192
ds_write_b64 v45, v[196:197] offset:8192
ds_write_b64 v46, v[200:201] offset:8192
ds_write_b64 v47, v[204:205] offset:8192
v_pk_mul_f32 v[208:209], v[208:209], s[66:67]
v_pk_mul_f32 v[210:211], v[210:211], s[66:67]
v_pk_mul_f32 v[212:213], v[212:213], s[66:67]
v_pk_mul_f32 v[214:215], v[214:215], s[66:67]
v_pk_mul_f32 v[216:217], v[216:217], s[66:67]
v_pk_mul_f32 v[218:219], v[218:219], s[66:67]
v_pk_mul_f32 v[220:221], v[220:221], s[66:67]
v_pk_mul_f32 v[222:223], v[222:223], s[66:67]
v_cvt_pk_bf16_f32 v208, v208, v209
v_cvt_pk_bf16_f32 v209, v210, v211
v_cvt_pk_bf16_f32 v212, v212, v213
v_cvt_pk_bf16_f32 v213, v214, v215
v_cvt_pk_bf16_f32 v216, v216, v217
v_cvt_pk_bf16_f32 v217, v218, v219
v_cvt_pk_bf16_f32 v220, v220, v221
v_cvt_pk_bf16_f32 v221, v222, v223
ds_write_b64 v112, v[208:209] offset:0
ds_write_b64 v113, v[212:213] offset:0
ds_write_b64 v114, v[216:217] offset:0
ds_write_b64 v115, v[220:221] offset:0
s_nop 3
v_pk_mul_f32 v[224:225], v[224:225], s[66:67]
v_pk_mul_f32 v[226:227], v[226:227], s[66:67]
v_pk_mul_f32 v[228:229], v[228:229], s[66:67]
v_pk_mul_f32 v[230:231], v[230:231], s[66:67]
v_pk_mul_f32 v[232:233], v[232:233], s[66:67]
v_pk_mul_f32 v[234:235], v[234:235], s[66:67]
v_pk_mul_f32 v[236:237], v[236:237], s[66:67]
v_pk_mul_f32 v[238:239], v[238:239], s[66:67]
v_cvt_pk_bf16_f32 v224, v224, v225
v_cvt_pk_bf16_f32 v225, v226, v227
v_cvt_pk_bf16_f32 v228, v228, v229
v_cvt_pk_bf16_f32 v229, v230, v231
v_cvt_pk_bf16_f32 v232, v232, v233
v_cvt_pk_bf16_f32 v233, v234, v235
v_cvt_pk_bf16_f32 v236, v236, v237
v_cvt_pk_bf16_f32 v237, v238, v239
ds_write_b64 v116, v[224:225] offset:0
ds_write_b64 v117, v[228:229] offset:0
ds_write_b64 v118, v[232:233] offset:0
ds_write_b64 v119, v[236:237] offset:0
s_mov_b32 s64, 4
s_mov_b32 s60, 24576
s_mov_b32 s61, 16384
s_mov_b32 s73, 1073741824
s_add_u32 s60, s79, 3
s_and_b32 s60, s60, 31
s_lshl_b32 s60, s60, 13
s_add_u32 s61, s79, 2
s_and_b32 s61, s61, 31
s_lshl_b32 s61, s61, 13
s_lshl_b32 s62, s3, 12
s_add_u32 s62, s62, 98304
s_mov_b32 m0, s62
s_waitcnt lgkmcnt(0)
s_barrier
ds_read_b128 a[96:99], v88
ds_read_b128 a[112:115], v92
ds_read_b128 a[128:131], v96
ds_read_b128 a[144:147], v100
ds_read_b128 a[160:163], v104
ds_read_b128 a[176:179], v108
ds_read_b128 a[100:103], v89
ds_read_b128 a[116:119], v93
ds_read_b128 a[132:135], v97
ds_read_b128 a[148:151], v101
ds_read_b128 a[164:167], v105
ds_read_b128 a[180:183], v109
ds_read_b128 a[104:107], v90
ds_read_b128 a[120:123], v94
ds_read_b128 a[136:139], v98
ds_read_b128 a[152:155], v102
ds_read_b128 a[168:171], v106
ds_read_b128 a[184:187], v110
ds_read_b128 a[108:111], v91
ds_read_b128 a[124:127], v95
ds_read_b128 a[140:143], v99
ds_read_b128 a[156:159], v103
ds_read_b128 a[172:175], v107
ds_read_b128 a[188:191], v111
L_main:
ds_read_b128 a[192:195], v4 offset:0
ds_read_b128 a[196:199], v5 offset:0
ds_read_b128 a[200:203], v6 offset:0
s_waitcnt lgkmcnt(2)
v_mfma_f32_16x16x32_bf16 v[24:27], a[192:195], a[96:99], v[120:123]
ds_read_b128 a[204:207], v7 offset:0
v_mfma_f32_16x16x32_bf16 v[28:31], a[192:195], a[112:115], v[124:127]
v_mfma_f32_16x16x32_bf16 v[32:35], a[192:195], a[128:131], v[128:131]
v_mfma_f32_16x16x32_bf16 v[36:39], a[192:195], a[144:147], v[132:135]
v_mfma_f32_16x16x32_bf16 v[40:43], a[192:195], a[160:163], v[136:139]
v_mfma_f32_16x16x32_bf16 v[44:47], a[192:195], a[176:179], v[140:143]
s_waitcnt lgkmcnt(2)
v_mfma_f32_16x16x32_bf16 v[24:27], a[196:199], a[100:103], v[24:27]
ds_read_b128 a[192:195], v4 offset:4096
v_mfma_f32_16x16x32_bf16 v[28:31], a[196:199], a[116:119], v[28:31]
v_mfma_f32_16x16x32_bf16 v[32:35], a[196:199], a[132:135], v[32:35]
buffer_load_dwordx4 v2, s[20:23], s60 offen offset:2048 nt lds
v_mfma_f32_16x16x32_bf16 v[36:39], a[196:199], a[148:151], v[36:39]
v_mfma_f32_16x16x32_bf16 v[40:43], a[196:199], a[164:167], v[40:43]
v_mfma_f32_16x16x32_bf16 v[44:47], a[196:199], a[180:183], v[44:47]
s_waitcnt lgkmcnt(2)
v_mfma_f32_16x16x32_bf16 v[24:27], a[200:203], a[104:107], v[24:27]
ds_read_b128 a[196:199], v5 offset:4096
v_mfma_f32_16x16x32_bf16 v[28:31], a[200:203], a[120:123], v[28:31]
v_mfma_f32_16x16x32_bf16 v[32:35], a[200:203], a[136:139], v[32:35]
v_mfma_f32_16x16x32_bf16 v[36:39], a[200:203], a[152:155], v[36:39]
v_mfma_f32_16x16x32_bf16 v[40:43], a[200:203], a[168:171], v[40:43]
v_mfma_f32_16x16x32_bf16 v[44:47], a[200:203], a[184:187], v[44:47]
s_waitcnt lgkmcnt(2)
v_mfma_f32_16x16x32_bf16 v[24:27], a[204:207], a[108:111], v[24:27]
ds_read_b128 a[200:203], v6 offset:4096
v_mfma_f32_16x16x32_bf16 v[28:31], a[204:207], a[124:127], v[28:31]
v_mfma_f32_16x16x32_bf16 v[32:35], a[204:207], a[140:143], v[32:35]
buffer_load_dwordx4 v3, s[20:23], s60 offen offset:3072 nt lds
v_mfma_f32_16x16x32_bf16 v[36:39], a[204:207], a[156:159], v[36:39]
v_mfma_f32_16x16x32_bf16 v[40:43], a[204:207], a[172:175], v[40:43]
v_mfma_f32_16x16x32_bf16 v[44:47], a[204:207], a[188:191], v[44:47]
s_waitcnt lgkmcnt(2)
v_mfma_f32_16x16x32_bf16 v[48:51], a[192:195], a[96:99], v[120:123]
ds_read_b128 a[204:207], v7 offset:4096
v_mfma_f32_16x16x32_bf16 v[52:55], a[192:195], a[112:115], v[124:127]
v_mfma_f32_16x16x32_bf16 v[56:59], a[192:195], a[128:131], v[128:131]
v_exp_f32 v24, v24
v_mfma_f32_16x16x32_bf16 v[60:63], a[192:195], a[144:147], v[132:135]
v_exp_f32 v25, v25
v_mfma_f32_16x16x32_bf16 v[64:67], a[192:195], a[160:163], v[136:139]
v_exp_f32 v26, v26
v_mfma_f32_16x16x32_bf16 v[68:71], a[192:195], a[176:179], v[140:143]
v_exp_f32 v27, v27
s_waitcnt lgkmcnt(2)
v_mfma_f32_16x16x32_bf16 v[48:51], a[196:199], a[100:103], v[48:51]
v_add_f32 v16, v16, v24
v_cvt_pk_bf16_f32 v72, v24, v25
s_add_u32 m0, s62, 16384
v_mfma_f32_16x16x32_bf16 v[52:55], a[196:199], a[116:119], v[52:55]
v_add_f32 v16, v16, v25
v_cvt_pk_bf16_f32 v73, v26, v27
v_mfma_f32_16x16x32_bf16 v[56:59], a[196:199], a[132:135], v[56:59]
v_add_f32 v16, v16, v26
v_add_f32 v16, v16, v27
buffer_load_dwordx4 v2, s[24:27], s61 offen offset:0 nt lds
v_mfma_f32_16x16x32_bf16 v[60:63], a[196:199], a[148:151], v[60:63]
v_exp_f32 v28, v28
v_mfma_f32_16x16x32_bf16 v[64:67], a[196:199], a[164:167], v[64:67]
v_exp_f32 v29, v29
v_mfma_f32_16x16x32_bf16 v[68:71], a[196:199], a[180:183], v[68:71]
v_exp_f32 v30, v30
s_waitcnt lgkmcnt(1)
v_mfma_f32_16x16x32_bf16 v[48:51], a[200:203], a[104:107], v[48:51]
v_exp_f32 v31, v31
v_mfma_f32_16x16x32_bf16 v[52:55], a[200:203], a[120:123], v[52:55]
v_add_f32 v17, v17, v28
v_cvt_pk_bf16_f32 v76, v28, v29
v_mfma_f32_16x16x32_bf16 v[56:59], a[200:203], a[136:139], v[56:59]
v_add_f32 v17, v17, v29
v_cvt_pk_bf16_f32 v77, v30, v31
v_mfma_f32_16x16x32_bf16 v[60:63], a[200:203], a[152:155], v[60:63]
v_add_f32 v17, v17, v30
v_add_f32 v17, v17, v31
v_mfma_f32_16x16x32_bf16 v[64:67], a[200:203], a[168:171], v[64:67]
v_exp_f32 v32, v32
v_mfma_f32_16x16x32_bf16 v[68:71], a[200:203], a[184:187], v[68:71]
v_exp_f32 v33, v33
s_waitcnt lgkmcnt(0)
v_mfma_f32_16x16x32_bf16 v[48:51], a[204:207], a[108:111], v[48:51]
v_exp_f32 v34, v34
v_mfma_f32_16x16x32_bf16 v[52:55], a[204:207], a[124:127], v[52:55]
v_exp_f32 v35, v35
v_mfma_f32_16x16x32_bf16 v[56:59], a[204:207], a[140:143], v[56:59]
v_add_f32 v18, v18, v32
v_cvt_pk_bf16_f32 v80, v32, v33
buffer_load_dwordx4 v3, s[24:27], s61 offen offset:1024 nt lds
v_mfma_f32_16x16x32_bf16 v[60:63], a[204:207], a[156:159], v[60:63]
v_add_f32 v18, v18, v33
v_cvt_pk_bf16_f32 v81, v34, v35
v_mfma_f32_16x16x32_bf16 v[64:67], a[204:207], a[172:175], v[64:67]
v_add_f32 v18, v18, v34
v_add_f32 v18, v18, v35
v_mfma_f32_16x16x32_bf16 v[68:71], a[204:207], a[188:191], v[68:71]
v_exp_f32 v36, v36
v_exp_f32 v37, v37
v_exp_f32 v38, v38
v_exp_f32 v39, v39
v_add_f32 v19, v19, v36
v_cvt_pk_bf16_f32 v84, v36, v37
v_add_f32 v19, v19, v37
v_cvt_pk_bf16_f32 v85, v38, v39
v_add_f32 v19, v19, v38
v_add_f32 v19, v19, v39
v_exp_f32 v40, v40
v_exp_f32 v41, v41
v_exp_f32 v42, v42
buffer_load_dwordx4 v2, s[24:27], s61 offen offset:2048 nt lds
v_exp_f32 v43, v43
v_add_f32 v20, v20, v40
v_cvt_pk_bf16_f32 v88, v40, v41
v_add_f32 v20, v20, v41
v_cvt_pk_bf16_f32 v89, v42, v43
v_add_f32 v20, v20, v42
v_add_f32 v20, v20, v43
v_exp_f32 v44, v44
v_exp_f32 v45, v45
v_exp_f32 v46, v46
v_exp_f32 v47, v47
v_add_f32 v21, v21, v44
v_cvt_pk_bf16_f32 v92, v44, v45
v_add_f32 v21, v21, v45
v_cvt_pk_bf16_f32 v93, v46, v47
v_add_f32 v21, v21, v46
v_add_f32 v21, v21, v47
v_exp_f32 v48, v48
buffer_load_dwordx4 v3, s[24:27], s61 offen offset:3072 nt lds
v_exp_f32 v49, v49
v_exp_f32 v50, v50
v_exp_f32 v51, v51
v_add_f32 v16, v16, v48
v_cvt_pk_bf16_f32 v74, v48, v49
s_add_u32 s56, s64, s79
v_add_f32 v16, v16, v49
v_cvt_pk_bf16_f32 v75, v50, v51
s_and_b32 s56, s56, 31
v_add_f32 v16, v16, v50
v_add_f32 v16, v16, v51
s_mov_b32 s61, s60
s_lshl_b32 s60, s56, 13
v_exp_f32 v52, v52
s_cmp_lt_u32 s64, 32
s_cselect_b32 s60, s60, s73
v_exp_f32 v53, v53
s_add_u32 s64, s64, 1
v_exp_f32 v54, v54
s_add_u32 s62, s62, 32768
s_and_b32 s62, s62, 0x1ffff
v_exp_f32 v55, v55
v_add_f32 v17, v17, v52
v_cvt_pk_bf16_f32 v78, v52, v53
v_add_f32 v17, v17, v53
v_cvt_pk_bf16_f32 v79, v54, v55
v_add_f32 v17, v17, v54
v_add_f32 v17, v17, v55
s_waitcnt vmcnt(16) lgkmcnt(0)
s_barrier
ds_read_b128 a[192:195], v4 offset:32768
v_exp_f32 v56, v56
s_mov_b32 m0, s62
v_exp_f32 v57, v57
ds_read_b128 a[196:199], v5 offset:32768
v_exp_f32 v58, v58
buffer_load_dwordx4 v2, s[20:23], s60 offen offset:0 nt lds
v_exp_f32 v59, v59
v_add_f32 v18, v18, v56
v_cvt_pk_bf16_f32 v82, v56, v57
v_add_f32 v18, v18, v57
v_cvt_pk_bf16_f32 v83, v58, v59
v_add_f32 v18, v18, v58
v_add_f32 v18, v18, v59
v_exp_f32 v60, v60
ds_read_b128 a[200:203], v6 offset:32768
v_exp_f32 v61, v61
v_exp_f32 v62, v62
v_exp_f32 v63, v63
buffer_load_dwordx4 v3, s[20:23], s60 offen offset:1024 nt lds
v_add_f32 v19, v19, v60
v_cvt_pk_bf16_f32 v86, v60, v61
v_add_f32 v19, v19, v61
v_cvt_pk_bf16_f32 v87, v62, v63
v_add_f32 v19, v19, v62
v_add_f32 v19, v19, v63
s_waitcnt lgkmcnt(2)
v_mfma_f32_16x16x32_bf16 v[24:27], a[192:195], a[96:99], v[120:123]
ds_read_b128 a[204:207], v7 offset:32768
v_exp_f32 v64, v64
v_mfma_f32_16x16x32_bf16 v[28:31], a[192:195], a[112:115], v[124:127]
v_exp_f32 v65, v65
v_mfma_f32_16x16x32_bf16 v[32:35], a[192:195], a[128:131], v[128:131]
v_exp_f32 v66, v66
v_mfma_f32_16x16x32_bf16 v[36:39], a[192:195], a[144:147], v[132:135]
v_exp_f32 v67, v67
v_mfma_f32_16x16x32_bf16 v[40:43], a[192:195], a[160:163], v[136:139]
v_add_f32 v20, v20, v64
v_cvt_pk_bf16_f32 v90, v64, v65
v_mfma_f32_16x16x32_bf16 v[44:47], a[192:195], a[176:179], v[140:143]
v_add_f32 v20, v20, v65
v_cvt_pk_bf16_f32 v91, v66, v67
s_waitcnt lgkmcnt(2)
v_mfma_f32_16x16x32_bf16 v[24:27], a[196:199], a[100:103], v[24:27]
ds_read_b128 a[192:195], v4 offset:36864
v_add_f32 v20, v20, v66
v_add_f32 v20, v20, v67
v_mfma_f32_16x16x32_bf16 v[28:31], a[196:199], a[116:119], v[28:31]
v_exp_f32 v68, v68
v_mfma_f32_16x16x32_bf16 v[32:35], a[196:199], a[132:135], v[32:35]
v_exp_f32 v69, v69
buffer_load_dwordx4 v2, s[20:23], s60 offen offset:2048 nt lds
v_mfma_f32_16x16x32_bf16 v[36:39], a[196:199], a[148:151], v[36:39]
v_exp_f32 v70, v70
v_mfma_f32_16x16x32_bf16 v[40:43], a[196:199], a[164:167], v[40:43]
v_exp_f32 v71, v71
v_mfma_f32_16x16x32_bf16 v[44:47], a[196:199], a[180:183], v[44:47]
v_add_f32 v21, v21, v68
v_cvt_pk_bf16_f32 v94, v68, v69
s_waitcnt lgkmcnt(2)
v_mfma_f32_16x16x32_bf16 v[24:27], a[200:203], a[104:107], v[24:27]
ds_read_b128 a[196:199], v5 offset:36864
v_add_f32 v21, v21, v69
v_cvt_pk_bf16_f32 v95, v70, v71
v_mfma_f32_16x16x32_bf16 v[28:31], a[200:203], a[120:123], v[28:31]
v_add_f32 v21, v21, v70
v_add_f32 v21, v21, v71
v_mfma_f32_16x16x32_bf16 v[32:35], a[200:203], a[136:139], v[32:35]
v_mfma_f32_16x16x32_bf16 v[36:39], a[200:203], a[152:155], v[36:39]
v_mfma_f32_16x16x32_bf16 v[40:43], a[200:203], a[168:171], v[40:43]
v_mfma_f32_16x16x32_bf16 v[44:47], a[200:203], a[184:187], v[44:47]
s_waitcnt lgkmcnt(2)
v_mfma_f32_16x16x32_bf16 v[24:27], a[204:207], a[108:111], v[24:27]
ds_read_b128 a[200:203], v6 offset:36864
v_mfma_f32_16x16x32_bf16 v[28:31], a[204:207], a[124:127], v[28:31]
v_mfma_f32_16x16x32_bf16 v[32:35], a[204:207], a[140:143], v[32:35]
buffer_load_dwordx4 v3, s[20:23], s60 offen offset:3072 nt lds
v_xor_b32 v4, 0x10000, v4
v_mfma_f32_16x16x32_bf16 v[36:39], a[204:207], a[156:159], v[36:39]
v_xor_b32 v5, 0x10000, v5
v_mfma_f32_16x16x32_bf16 v[40:43], a[204:207], a[172:175], v[40:43]
v_xor_b32 v6, 0x10000, v6
v_mfma_f32_16x16x32_bf16 v[44:47], a[204:207], a[188:191], v[44:47]
s_waitcnt lgkmcnt(2)
v_mfma_f32_16x16x32_bf16 v[48:51], a[192:195], a[96:99], v[120:123]
ds_read_b128 a[204:207], v7 offset:36864
v_mfma_f32_16x16x32_bf16 v[52:55], a[192:195], a[112:115], v[124:127]
v_mfma_f32_16x16x32_bf16 v[56:59], a[192:195], a[128:131], v[128:131]
v_exp_f32 v24, v24
v_mfma_f32_16x16x32_bf16 v[60:63], a[192:195], a[144:147], v[132:135]
v_exp_f32 v25, v25
v_xor_b32 v7, 0x10000, v7
v_mfma_f32_16x16x32_bf16 v[64:67], a[192:195], a[160:163], v[136:139]
v_exp_f32 v26, v26
v_mfma_f32_16x16x32_bf16 v[68:71], a[192:195], a[176:179], v[140:143]
v_exp_f32 v27, v27
s_waitcnt lgkmcnt(2)
v_mfma_f32_16x16x32_bf16 v[48:51], a[196:199], a[100:103], v[48:51]
ds_read_b64_tr_b16 a[192:193], v8 offset:32768
ds_read_b64_tr_b16 a[194:195], v8 offset:36864
v_add_f32 v16, v16, v24
v_cvt_pk_bf16_f32 v96, v24, v25
s_add_u32 m0, s62, 16384
v_mfma_f32_16x16x32_bf16 v[52:55], a[196:199], a[116:119], v[52:55]
v_add_f32 v16, v16, v25
v_cvt_pk_bf16_f32 v97, v26, v27
v_mfma_f32_16x16x32_bf16 v[56:59], a[196:199], a[132:135], v[56:59]
v_add_f32 v16, v16, v26
v_add_f32 v16, v16, v27
buffer_load_dwordx4 v2, s[24:27], s61 offen offset:0 nt lds
v_mfma_f32_16x16x32_bf16 v[60:63], a[196:199], a[148:151], v[60:63]
v_exp_f32 v28, v28
v_mfma_f32_16x16x32_bf16 v[64:67], a[196:199], a[164:167], v[64:67]
v_exp_f32 v29, v29
v_mfma_f32_16x16x32_bf16 v[68:71], a[196:199], a[180:183], v[68:71]
v_exp_f32 v30, v30
s_waitcnt lgkmcnt(3)
v_mfma_f32_16x16x32_bf16 v[48:51], a[200:203], a[104:107], v[48:51]
ds_read_b64_tr_b16 a[196:197], v9 offset:32768
ds_read_b64_tr_b16 a[198:199], v9 offset:36864
v_exp_f32 v31, v31
v_mfma_f32_16x16x32_bf16 v[52:55], a[200:203], a[120:123], v[52:55]
v_add_f32 v17, v17, v28
v_cvt_pk_bf16_f32 v100, v28, v29
v_mfma_f32_16x16x32_bf16 v[56:59], a[200:203], a[136:139], v[56:59]
v_add_f32 v17, v17, v29
v_cvt_pk_bf16_f32 v101, v30, v31
v_mfma_f32_16x16x32_bf16 v[60:63], a[200:203], a[152:155], v[60:63]
v_add_f32 v17, v17, v30
v_add_f32 v17, v17, v31
v_mfma_f32_16x16x32_bf16 v[64:67], a[200:203], a[168:171], v[64:67]
v_exp_f32 v32, v32
v_mfma_f32_16x16x32_bf16 v[68:71], a[200:203], a[184:187], v[68:71]
v_exp_f32 v33, v33
s_waitcnt lgkmcnt(4)
v_mfma_f32_16x16x32_bf16 v[48:51], a[204:207], a[108:111], v[48:51]
ds_read_b64_tr_b16 a[200:201], v10 offset:32768
ds_read_b64_tr_b16 a[202:203], v10 offset:36864
v_exp_f32 v34, v34
v_mfma_f32_16x16x32_bf16 v[52:55], a[204:207], a[124:127], v[52:55]
v_exp_f32 v35, v35
v_mfma_f32_16x16x32_bf16 v[56:59], a[204:207], a[140:143], v[56:59]
v_add_f32 v18, v18, v32
v_cvt_pk_bf16_f32 v104, v32, v33
buffer_load_dwordx4 v3, s[24:27], s61 offen offset:1024 nt lds
v_mfma_f32_16x16x32_bf16 v[60:63], a[204:207], a[156:159], v[60:63]
v_add_f32 v18, v18, v33
v_cvt_pk_bf16_f32 v105, v34, v35
v_mfma_f32_16x16x32_bf16 v[64:67], a[204:207], a[172:175], v[64:67]
v_add_f32 v18, v18, v34
v_add_f32 v18, v18, v35
v_mfma_f32_16x16x32_bf16 v[68:71], a[204:207], a[188:191], v[68:71]
v_exp_f32 v36, v36
s_waitcnt lgkmcnt(4)
v_mfma_f32_16x16x32_bf16 v[144:147], a[192:195], v[72:75], 0
ds_read_b64_tr_b16 a[204:205], v11 offset:32768
ds_read_b64_tr_b16 a[206:207], v11 offset:36864
v_exp_f32 v37, v37
v_mfma_f32_16x16x32_bf16 v[148:151], a[192:195], v[76:79], 0
v_exp_f32 v38, v38
v_mfma_f32_16x16x32_bf16 v[152:155], a[192:195], v[80:83], 0
v_exp_f32 v39, v39
v_mfma_f32_16x16x32_bf16 v[156:159], a[192:195], v[84:87], 0
v_add_f32 v19, v19, v36
v_cvt_pk_bf16_f32 v108, v36, v37
v_mfma_f32_16x16x32_bf16 v[160:163], a[192:195], v[88:91], 0
v_add_f32 v19, v19, v37
v_cvt_pk_bf16_f32 v109, v38, v39
v_mfma_f32_16x16x32_bf16 v[164:167], a[192:195], v[92:95], 0
v_add_f32 v19, v19, v38
v_add_f32 v19, v19, v39
s_waitcnt lgkmcnt(4)
v_mfma_f32_16x16x32_bf16 v[168:171], a[196:199], v[72:75], 0
ds_read_b64_tr_b16 a[192:193], v12 offset:32768
ds_read_b64_tr_b16 a[194:195], v12 offset:36864
v_exp_f32 v40, v40
v_mfma_f32_16x16x32_bf16 v[172:175], a[196:199], v[76:79], 0
v_exp_f32 v41, v41
v_mfma_f32_16x16x32_bf16 v[176:179], a[196:199], v[80:83], 0
v_exp_f32 v42, v42
buffer_load_dwordx4 v2, s[24:27], s61 offen offset:2048 nt lds
v_mfma_f32_16x16x32_bf16 v[180:183], a[196:199], v[84:87], 0
v_exp_f32 v43, v43
v_mfma_f32_16x16x32_bf16 v[184:187], a[196:199], v[88:91], 0
v_add_f32 v20, v20, v40
v_cvt_pk_bf16_f32 v112, v40, v41
v_mfma_f32_16x16x32_bf16 v[188:191], a[196:199], v[92:95], 0
v_add_f32 v20, v20, v41
v_cvt_pk_bf16_f32 v113, v42, v43
s_waitcnt lgkmcnt(4)
v_mfma_f32_16x16x32_bf16 v[192:195], a[200:203], v[72:75], 0
ds_read_b64_tr_b16 a[196:197], v13 offset:32768
ds_read_b64_tr_b16 a[198:199], v13 offset:36864
v_add_f32 v20, v20, v42
v_add_f32 v20, v20, v43
v_mfma_f32_16x16x32_bf16 v[196:199], a[200:203], v[76:79], 0
v_exp_f32 v44, v44
v_mfma_f32_16x16x32_bf16 v[200:203], a[200:203], v[80:83], 0
v_exp_f32 v45, v45
v_mfma_f32_16x16x32_bf16 v[204:207], a[200:203], v[84:87], 0
v_exp_f32 v46, v46
v_mfma_f32_16x16x32_bf16 v[208:211], a[200:203], v[88:91], 0
v_exp_f32 v47, v47
v_mfma_f32_16x16x32_bf16 v[212:215], a[200:203], v[92:95], 0
v_add_f32 v21, v21, v44
v_cvt_pk_bf16_f32 v116, v44, v45
s_waitcnt lgkmcnt(4)
v_mfma_f32_16x16x32_bf16 v[216:219], a[204:207], v[72:75], 0
ds_read_b64_tr_b16 a[200:201], v14 offset:32768
ds_read_b64_tr_b16 a[202:203], v14 offset:36864
v_add_f32 v21, v21, v45
v_cvt_pk_bf16_f32 v117, v46, v47
v_mfma_f32_16x16x32_bf16 v[220:223], a[204:207], v[76:79], 0
v_add_f32 v21, v21, v46
v_add_f32 v21, v21, v47
v_mfma_f32_16x16x32_bf16 v[224:227], a[204:207], v[80:83], 0
v_exp_f32 v48, v48
buffer_load_dwordx4 v3, s[24:27], s61 offen offset:3072 nt lds
v_mfma_f32_16x16x32_bf16 v[228:231], a[204:207], v[84:87], 0
v_exp_f32 v49, v49
v_mfma_f32_16x16x32_bf16 v[232:235], a[204:207], v[88:91], 0
v_exp_f32 v50, v50
v_mfma_f32_16x16x32_bf16 v[236:239], a[204:207], v[92:95], 0
v_exp_f32 v51, v51
s_waitcnt lgkmcnt(4)
v_mfma_f32_16x16x32_bf16 a[0:3], a[192:195], v[72:75], 0
ds_read_b64_tr_b16 a[204:205], v15 offset:32768
ds_read_b64_tr_b16 a[206:207], v15 offset:36864
v_add_f32 v16, v16, v48
v_cvt_pk_bf16_f32 v98, v48, v49
s_add_u32 s56, s64, s79
v_mfma_f32_16x16x32_bf16 a[4:7], a[192:195], v[76:79], 0
v_add_f32 v16, v16, v49
v_cvt_pk_bf16_f32 v99, v50, v51
s_and_b32 s56, s56, 31
v_mfma_f32_16x16x32_bf16 a[8:11], a[192:195], v[80:83], 0
v_add_f32 v16, v16, v50
v_add_f32 v16, v16, v51
s_mov_b32 s61, s60
s_lshl_b32 s60, s56, 13
v_mfma_f32_16x16x32_bf16 a[12:15], a[192:195], v[84:87], 0
v_exp_f32 v52, v52
s_cmp_lt_u32 s64, 32
s_cselect_b32 s60, s60, s73
v_mfma_f32_16x16x32_bf16 a[16:19], a[192:195], v[88:91], 0
v_exp_f32 v53, v53
s_add_u32 s64, s64, 1
v_mfma_f32_16x16x32_bf16 a[20:23], a[192:195], v[92:95], 0
v_exp_f32 v54, v54
s_add_u32 s62, s62, 32768
s_and_b32 s62, s62, 0x1ffff
s_waitcnt lgkmcnt(4)
v_mfma_f32_16x16x32_bf16 a[24:27], a[196:199], v[72:75], 0
v_exp_f32 v55, v55
v_mfma_f32_16x16x32_bf16 a[28:31], a[196:199], v[76:79], 0
v_add_f32 v17, v17, v52
v_cvt_pk_bf16_f32 v102, v52, v53
v_mfma_f32_16x16x32_bf16 a[32:35], a[196:199], v[80:83], 0
v_add_f32 v17, v17, v53
v_cvt_pk_bf16_f32 v103, v54, v55
v_mfma_f32_16x16x32_bf16 a[36:39], a[196:199], v[84:87], 0
v_add_f32 v17, v17, v54
v_add_f32 v17, v17, v55
s_waitcnt vmcnt(16) lgkmcnt(0)
s_barrier
v_mfma_f32_16x16x32_bf16 a[40:43], a[196:199], v[88:91], 0
ds_read_b128 a[192:195], v4 offset:0
v_exp_f32 v56, v56
s_mov_b32 m0, s62
v_mfma_f32_16x16x32_bf16 a[44:47], a[196:199], v[92:95], 0
v_exp_f32 v57, v57
v_mfma_f32_16x16x32_bf16 a[48:51], a[200:203], v[72:75], 0
ds_read_b128 a[196:199], v5 offset:0
v_exp_f32 v58, v58
buffer_load_dwordx4 v2, s[20:23], s60 offen offset:0 nt lds
v_mfma_f32_16x16x32_bf16 a[52:55], a[200:203], v[76:79], 0
v_exp_f32 v59, v59
v_mfma_f32_16x16x32_bf16 a[56:59], a[200:203], v[80:83], 0
v_add_f32 v18, v18, v56
v_cvt_pk_bf16_f32 v106, v56, v57
v_mfma_f32_16x16x32_bf16 a[60:63], a[200:203], v[84:87], 0
v_add_f32 v18, v18, v57
v_cvt_pk_bf16_f32 v107, v58, v59
v_mfma_f32_16x16x32_bf16 a[64:67], a[200:203], v[88:91], 0
v_add_f32 v18, v18, v58
v_add_f32 v18, v18, v59
v_mfma_f32_16x16x32_bf16 a[68:71], a[200:203], v[92:95], 0
v_exp_f32 v60, v60
v_mfma_f32_16x16x32_bf16 a[72:75], a[204:207], v[72:75], 0
ds_read_b128 a[200:203], v6 offset:0
v_exp_f32 v61, v61
v_mfma_f32_16x16x32_bf16 a[76:79], a[204:207], v[76:79], 0
v_exp_f32 v62, v62
v_mfma_f32_16x16x32_bf16 a[80:83], a[204:207], v[80:83], 0
v_exp_f32 v63, v63
buffer_load_dwordx4 v3, s[20:23], s60 offen offset:1024 nt lds
v_mfma_f32_16x16x32_bf16 a[84:87], a[204:207], v[84:87], 0
v_add_f32 v19, v19, v60
v_cvt_pk_bf16_f32 v110, v60, v61
v_mfma_f32_16x16x32_bf16 a[88:91], a[204:207], v[88:91], 0
v_add_f32 v19, v19, v61
v_cvt_pk_bf16_f32 v111, v62, v63
v_mfma_f32_16x16x32_bf16 a[92:95], a[204:207], v[92:95], 0
v_add_f32 v19, v19, v62
v_add_f32 v19, v19, v63
s_mov_b32 s53, 14
s_and_b32 s54, s2, 1
s_cmp_eq_u32 s54, 0
s_cselect_b64 vcc, -1, 0
.p2align 6
L_loop:
s_waitcnt lgkmcnt(2)
v_mfma_f32_16x16x32_bf16 v[24:27], a[192:195], a[96:99], v[120:123]
ds_read_b128 a[204:207], v7 offset:0
v_exp_f32 v64, v64
v_mfma_f32_16x16x32_bf16 v[28:31], a[192:195], a[112:115], v[124:127]
v_exp_f32 v65, v65
v_mfma_f32_16x16x32_bf16 v[32:35], a[192:195], a[128:131], v[128:131]
v_exp_f32 v66, v66
v_mfma_f32_16x16x32_bf16 v[36:39], a[192:195], a[144:147], v[132:135]
v_exp_f32 v67, v67
v_mfma_f32_16x16x32_bf16 v[40:43], a[192:195], a[160:163], v[136:139]
v_add_f32 v20, v20, v64
v_cvt_pk_bf16_f32 v114, v64, v65
v_mfma_f32_16x16x32_bf16 v[44:47], a[192:195], a[176:179], v[140:143]
v_add_f32 v20, v20, v65
v_cvt_pk_bf16_f32 v115, v66, v67
s_waitcnt lgkmcnt(2)
v_mfma_f32_16x16x32_bf16 v[24:27], a[196:199], a[100:103], v[24:27]
ds_read_b128 a[192:195], v4 offset:4096
v_add_f32 v20, v20, v66
v_add_f32 v20, v20, v67
v_mfma_f32_16x16x32_bf16 v[28:31], a[196:199], a[116:119], v[28:31]
v_exp_f32 v68, v68
v_mfma_f32_16x16x32_bf16 v[32:35], a[196:199], a[132:135], v[32:35]
v_exp_f32 v69, v69
s_cbranch_vccnz L_thr0
L_thr0_ret:
buffer_load_dwordx4 v2, s[20:23], s60 offen offset:2048 nt lds
v_mfma_f32_16x16x32_bf16 v[36:39], a[196:199], a[148:151], v[36:39]
v_exp_f32 v70, v70
v_mfma_f32_16x16x32_bf16 v[40:43], a[196:199], a[164:167], v[40:43]
v_exp_f32 v71, v71
v_mfma_f32_16x16x32_bf16 v[44:47], a[196:199], a[180:183], v[44:47]
v_add_f32 v21, v21, v68
v_cvt_pk_bf16_f32 v118, v68, v69
s_waitcnt lgkmcnt(2)
v_mfma_f32_16x16x32_bf16 v[24:27], a[200:203], a[104:107], v[24:27]
ds_read_b128 a[196:199], v5 offset:4096
v_add_f32 v21, v21, v69
v_cvt_pk_bf16_f32 v119, v70, v71
v_mfma_f32_16x16x32_bf16 v[28:31], a[200:203], a[120:123], v[28:31]
v_add_f32 v21, v21, v70
v_add_f32 v21, v21, v71
v_mfma_f32_16x16x32_bf16 v[32:35], a[200:203], a[136:139], v[32:35]
v_mfma_f32_16x16x32_bf16 v[36:39], a[200:203], a[152:155], v[36:39]
v_xor_b32 v8, 0x10000, v8
v_mfma_f32_16x16x32_bf16 v[40:43], a[200:203], a[168:171], v[40:43]
v_xor_b32 v9, 0x10000, v9
v_mfma_f32_16x16x32_bf16 v[44:47], a[200:203], a[184:187], v[44:47]
v_xor_b32 v10, 0x10000, v10
s_waitcnt lgkmcnt(2)
v_mfma_f32_16x16x32_bf16 v[24:27], a[204:207], a[108:111], v[24:27]
ds_read_b128 a[200:203], v6 offset:4096
v_xor_b32 v11, 0x10000, v11
v_mfma_f32_16x16x32_bf16 v[28:31], a[204:207], a[124:127], v[28:31]
v_xor_b32 v12, 0x10000, v12
v_mfma_f32_16x16x32_bf16 v[32:35], a[204:207], a[140:143], v[32:35]
buffer_load_dwordx4 v3, s[20:23], s60 offen offset:3072 nt lds
v_xor_b32 v13, 0x10000, v13
v_mfma_f32_16x16x32_bf16 v[36:39], a[204:207], a[156:159], v[36:39]
v_xor_b32 v14, 0x10000, v14
v_mfma_f32_16x16x32_bf16 v[40:43], a[204:207], a[172:175], v[40:43]
v_xor_b32 v15, 0x10000, v15
v_mfma_f32_16x16x32_bf16 v[44:47], a[204:207], a[188:191], v[44:47]
s_waitcnt lgkmcnt(2)
v_mfma_f32_16x16x32_bf16 v[48:51], a[192:195], a[96:99], v[120:123]
ds_read_b128 a[204:207], v7 offset:4096
v_mfma_f32_16x16x32_bf16 v[52:55], a[192:195], a[112:115], v[124:127]
v_mfma_f32_16x16x32_bf16 v[56:59], a[192:195], a[128:131], v[128:131]
v_exp_f32 v24, v24
v_mfma_f32_16x16x32_bf16 v[60:63], a[192:195], a[144:147], v[132:135]
v_exp_f32 v25, v25
v_mfma_f32_16x16x32_bf16 v[64:67], a[192:195], a[160:163], v[136:139]
v_exp_f32 v26, v26
v_mfma_f32_16x16x32_bf16 v[68:71], a[192:195], a[176:179], v[140:143]
v_exp_f32 v27, v27
s_waitcnt lgkmcnt(2)
v_mfma_f32_16x16x32_bf16 v[48:51], a[196:199], a[100:103], v[48:51]
ds_read_b64_tr_b16 a[192:193], v8 offset:0
ds_read_b64_tr_b16 a[194:195], v8 offset:4096
v_add_f32 v16, v16, v24
v_cvt_pk_bf16_f32 v72, v24, v25
s_add_u32 m0, s62, 16384
v_mfma_f32_16x16x32_bf16 v[52:55], a[196:199], a[116:119], v[52:55]
v_add_f32 v16, v16, v25
v_cvt_pk_bf16_f32 v73, v26, v27
v_mfma_f32_16x16x32_bf16 v[56:59], a[196:199], a[132:135], v[56:59]
v_add_f32 v16, v16, v26
v_add_f32 v16, v16, v27
s_cbranch_vccnz L_thr1
L_thr1_ret:
buffer_load_dwordx4 v2, s[24:27], s61 offen offset:0 nt lds
v_mfma_f32_16x16x32_bf16 v[60:63], a[196:199], a[148:151], v[60:63]
v_exp_f32 v28, v28
v_mfma_f32_16x16x32_bf16 v[64:67], a[196:199], a[164:167], v[64:67]
v_exp_f32 v29, v29
v_mfma_f32_16x16x32_bf16 v[68:71], a[196:199], a[180:183], v[68:71]
v_exp_f32 v30, v30
s_waitcnt lgkmcnt(3)
v_mfma_f32_16x16x32_bf16 v[48:51], a[200:203], a[104:107], v[48:51]
ds_read_b64_tr_b16 a[196:197], v9 offset:0
ds_read_b64_tr_b16 a[198:199], v9 offset:4096
v_exp_f32 v31, v31
v_mfma_f32_16x16x32_bf16 v[52:55], a[200:203], a[120:123], v[52:55]
v_add_f32 v17, v17, v28
v_cvt_pk_bf16_f32 v76, v28, v29
v_mfma_f32_16x16x32_bf16 v[56:59], a[200:203], a[136:139], v[56:59]
v_add_f32 v17, v17, v29
v_cvt_pk_bf16_f32 v77, v30, v31
v_mfma_f32_16x16x32_bf16 v[60:63], a[200:203], a[152:155], v[60:63]
v_add_f32 v17, v17, v30
v_add_f32 v17, v17, v31
v_mfma_f32_16x16x32_bf16 v[64:67], a[200:203], a[168:171], v[64:67]
v_exp_f32 v32, v32
v_mfma_f32_16x16x32_bf16 v[68:71], a[200:203], a[184:187], v[68:71]
v_exp_f32 v33, v33
s_waitcnt lgkmcnt(4)
v_mfma_f32_16x16x32_bf16 v[48:51], a[204:207], a[108:111], v[48:51]
ds_read_b64_tr_b16 a[200:201], v10 offset:0
ds_read_b64_tr_b16 a[202:203], v10 offset:4096
v_exp_f32 v34, v34
v_mfma_f32_16x16x32_bf16 v[52:55], a[204:207], a[124:127], v[52:55]
v_exp_f32 v35, v35
v_mfma_f32_16x16x32_bf16 v[56:59], a[204:207], a[140:143], v[56:59]
v_add_f32 v18, v18, v32
v_cvt_pk_bf16_f32 v80, v32, v33
buffer_load_dwordx4 v3, s[24:27], s61 offen offset:1024 nt lds
v_mfma_f32_16x16x32_bf16 v[60:63], a[204:207], a[156:159], v[60:63]
v_add_f32 v18, v18, v33
v_cvt_pk_bf16_f32 v81, v34, v35
v_mfma_f32_16x16x32_bf16 v[64:67], a[204:207], a[172:175], v[64:67]
v_add_f32 v18, v18, v34
v_add_f32 v18, v18, v35
v_mfma_f32_16x16x32_bf16 v[68:71], a[204:207], a[188:191], v[68:71]
v_exp_f32 v36, v36
s_waitcnt lgkmcnt(4)
v_mfma_f32_16x16x32_bf16 v[144:147], a[192:195], v[96:99], v[144:147]
ds_read_b64_tr_b16 a[204:205], v11 offset:0
ds_read_b64_tr_b16 a[206:207], v11 offset:4096
v_exp_f32 v37, v37
v_mfma_f32_16x16x32_bf16 v[148:151], a[192:195], v[100:103], v[148:151]
v_exp_f32 v38, v38
v_mfma_f32_16x16x32_bf16 v[152:155], a[192:195], v[104:107], v[152:155]
v_exp_f32 v39, v39
v_mfma_f32_16x16x32_bf16 v[156:159], a[192:195], v[108:111], v[156:159]
v_add_f32 v19, v19, v36
v_cvt_pk_bf16_f32 v84, v36, v37
v_mfma_f32_16x16x32_bf16 v[160:163], a[192:195], v[112:115], v[160:163]
v_add_f32 v19, v19, v37
v_cvt_pk_bf16_f32 v85, v38, v39
v_mfma_f32_16x16x32_bf16 v[164:167], a[192:195], v[116:119], v[164:167]
v_add_f32 v19, v19, v38
v_add_f32 v19, v19, v39
s_waitcnt lgkmcnt(4)
v_mfma_f32_16x16x32_bf16 v[168:171], a[196:199], v[96:99], v[168:171]
ds_read_b64_tr_b16 a[192:193], v12 offset:0
ds_read_b64_tr_b16 a[194:195], v12 offset:4096
v_exp_f32 v40, v40
v_mfma_f32_16x16x32_bf16 v[172:175], a[196:199], v[100:103], v[172:175]
v_exp_f32 v41, v41
v_mfma_f32_16x16x32_bf16 v[176:179], a[196:199], v[104:107], v[176:179]
v_exp_f32 v42, v42
s_cbranch_vccnz L_thr2
L_thr2_ret:
buffer_load_dwordx4 v2, s[24:27], s61 offen offset:2048 nt lds
v_mfma_f32_16x16x32_bf16 v[180:183], a[196:199], v[108:111], v[180:183]
v_exp_f32 v43, v43
v_mfma_f32_16x16x32_bf16 v[184:187], a[196:199], v[112:115], v[184:187]
v_add_f32 v20, v20, v40
v_cvt_pk_bf16_f32 v88, v40, v41
v_mfma_f32_16x16x32_bf16 v[188:191], a[196:199], v[116:119], v[188:191]
v_add_f32 v20, v20, v41
v_cvt_pk_bf16_f32 v89, v42, v43
s_waitcnt lgkmcnt(4)
v_mfma_f32_16x16x32_bf16 v[192:195], a[200:203], v[96:99], v[192:195]
ds_read_b64_tr_b16 a[196:197], v13 offset:0
ds_read_b64_tr_b16 a[198:199], v13 offset:4096
v_add_f32 v20, v20, v42
v_add_f32 v20, v20, v43
v_mfma_f32_16x16x32_bf16 v[196:199], a[200:203], v[100:103], v[196:199]
v_exp_f32 v44, v44
v_mfma_f32_16x16x32_bf16 v[200:203], a[200:203], v[104:107], v[200:203]
v_exp_f32 v45, v45
v_mfma_f32_16x16x32_bf16 v[204:207], a[200:203], v[108:111], v[204:207]
v_exp_f32 v46, v46
v_mfma_f32_16x16x32_bf16 v[208:211], a[200:203], v[112:115], v[208:211]
v_exp_f32 v47, v47
v_mfma_f32_16x16x32_bf16 v[212:215], a[200:203], v[116:119], v[212:215]
v_add_f32 v21, v21, v44
v_cvt_pk_bf16_f32 v92, v44, v45
s_waitcnt lgkmcnt(4)
v_mfma_f32_16x16x32_bf16 v[216:219], a[204:207], v[96:99], v[216:219]
ds_read_b64_tr_b16 a[200:201], v14 offset:0
ds_read_b64_tr_b16 a[202:203], v14 offset:4096
v_add_f32 v21, v21, v45
v_cvt_pk_bf16_f32 v93, v46, v47
v_mfma_f32_16x16x32_bf16 v[220:223], a[204:207], v[100:103], v[220:223]
v_add_f32 v21, v21, v46
v_add_f32 v21, v21, v47
v_mfma_f32_16x16x32_bf16 v[224:227], a[204:207], v[104:107], v[224:227]
v_exp_f32 v48, v48
buffer_load_dwordx4 v3, s[24:27], s61 offen offset:3072 nt lds
v_mfma_f32_16x16x32_bf16 v[228:231], a[204:207], v[108:111], v[228:231]
v_exp_f32 v49, v49
v_mfma_f32_16x16x32_bf16 v[232:235], a[204:207], v[112:115], v[232:235]
v_exp_f32 v50, v50
v_mfma_f32_16x16x32_bf16 v[236:239], a[204:207], v[116:119], v[236:239]
v_exp_f32 v51, v51
s_waitcnt lgkmcnt(4)
v_mfma_f32_16x16x32_bf16 a[0:3], a[192:195], v[96:99], a[0:3]
ds_read_b64_tr_b16 a[204:205], v15 offset:0
ds_read_b64_tr_b16 a[206:207], v15 offset:4096
v_add_f32 v16, v16, v48
v_cvt_pk_bf16_f32 v74, v48, v49
s_add_u32 s56, s64, s79
v_mfma_f32_16x16x32_bf16 a[4:7], a[192:195], v[100:103], a[4:7]
v_add_f32 v16, v16, v49
v_cvt_pk_bf16_f32 v75, v50, v51
s_and_b32 s56, s56, 31
v_mfma_f32_16x16x32_bf16 a[8:11], a[192:195], v[104:107], a[8:11]
v_add_f32 v16, v16, v50
v_add_f32 v16, v16, v51
s_mov_b32 s61, s60
s_lshl_b32 s60, s56, 13
v_mfma_f32_16x16x32_bf16 a[12:15], a[192:195], v[108:111], a[12:15]
v_exp_f32 v52, v52
s_cmp_lt_u32 s64, 32
s_cselect_b32 s60, s60, s73
v_mfma_f32_16x16x32_bf16 a[16:19], a[192:195], v[112:115], a[16:19]
v_exp_f32 v53, v53
s_add_u32 s64, s64, 1
v_mfma_f32_16x16x32_bf16 a[20:23], a[192:195], v[116:119], a[20:23]
v_exp_f32 v54, v54
s_add_u32 s62, s62, 32768
s_and_b32 s62, s62, 0x1ffff
s_waitcnt lgkmcnt(4)
v_mfma_f32_16x16x32_bf16 a[24:27], a[196:199], v[96:99], a[24:27]
v_exp_f32 v55, v55
v_mfma_f32_16x16x32_bf16 a[28:31], a[196:199], v[100:103], a[28:31]
v_add_f32 v17, v17, v52
v_cvt_pk_bf16_f32 v78, v52, v53
v_mfma_f32_16x16x32_bf16 a[32:35], a[196:199], v[104:107], a[32:35]
v_add_f32 v17, v17, v53
v_cvt_pk_bf16_f32 v79, v54, v55
v_mfma_f32_16x16x32_bf16 a[36:39], a[196:199], v[108:111], a[36:39]
v_add_f32 v17, v17, v54
v_add_f32 v17, v17, v55
s_waitcnt vmcnt(16) lgkmcnt(0)
s_barrier
v_mfma_f32_16x16x32_bf16 a[40:43], a[196:199], v[112:115], a[40:43]
ds_read_b128 a[192:195], v4 offset:32768
v_exp_f32 v56, v56
s_mov_b32 m0, s62
v_mfma_f32_16x16x32_bf16 a[44:47], a[196:199], v[116:119], a[44:47]
v_exp_f32 v57, v57
v_mfma_f32_16x16x32_bf16 a[48:51], a[200:203], v[96:99], a[48:51]
ds_read_b128 a[196:199], v5 offset:32768
v_exp_f32 v58, v58
s_cbranch_vccnz L_thr3
L_thr3_ret:
buffer_load_dwordx4 v2, s[20:23], s60 offen offset:0 nt lds
v_mfma_f32_16x16x32_bf16 a[52:55], a[200:203], v[100:103], a[52:55]
v_exp_f32 v59, v59
v_mfma_f32_16x16x32_bf16 a[56:59], a[200:203], v[104:107], a[56:59]
v_add_f32 v18, v18, v56
v_cvt_pk_bf16_f32 v82, v56, v57
v_mfma_f32_16x16x32_bf16 a[60:63], a[200:203], v[108:111], a[60:63]
v_add_f32 v18, v18, v57
v_cvt_pk_bf16_f32 v83, v58, v59
v_mfma_f32_16x16x32_bf16 a[64:67], a[200:203], v[112:115], a[64:67]
v_add_f32 v18, v18, v58
v_add_f32 v18, v18, v59
v_mfma_f32_16x16x32_bf16 a[68:71], a[200:203], v[116:119], a[68:71]
v_exp_f32 v60, v60
v_mfma_f32_16x16x32_bf16 a[72:75], a[204:207], v[96:99], a[72:75]
ds_read_b128 a[200:203], v6 offset:32768
v_exp_f32 v61, v61
v_mfma_f32_16x16x32_bf16 a[76:79], a[204:207], v[100:103], a[76:79]
v_exp_f32 v62, v62
v_mfma_f32_16x16x32_bf16 a[80:83], a[204:207], v[104:107], a[80:83]
v_exp_f32 v63, v63
buffer_load_dwordx4 v3, s[20:23], s60 offen offset:1024 nt lds
v_mfma_f32_16x16x32_bf16 a[84:87], a[204:207], v[108:111], a[84:87]
v_add_f32 v19, v19, v60
v_cvt_pk_bf16_f32 v86, v60, v61
v_mfma_f32_16x16x32_bf16 a[88:91], a[204:207], v[112:115], a[88:91]
v_add_f32 v19, v19, v61
v_cvt_pk_bf16_f32 v87, v62, v63
v_mfma_f32_16x16x32_bf16 a[92:95], a[204:207], v[116:119], a[92:95]
v_add_f32 v19, v19, v62
v_add_f32 v19, v19, v63
s_waitcnt lgkmcnt(2)
v_mfma_f32_16x16x32_bf16 v[24:27], a[192:195], a[96:99], v[120:123]
ds_read_b128 a[204:207], v7 offset:32768
v_exp_f32 v64, v64
v_mfma_f32_16x16x32_bf16 v[28:31], a[192:195], a[112:115], v[124:127]
v_exp_f32 v65, v65
v_mfma_f32_16x16x32_bf16 v[32:35], a[192:195], a[128:131], v[128:131]
v_exp_f32 v66, v66
v_mfma_f32_16x16x32_bf16 v[36:39], a[192:195], a[144:147], v[132:135]
v_exp_f32 v67, v67
v_mfma_f32_16x16x32_bf16 v[40:43], a[192:195], a[160:163], v[136:139]
v_add_f32 v20, v20, v64
v_cvt_pk_bf16_f32 v90, v64, v65
v_mfma_f32_16x16x32_bf16 v[44:47], a[192:195], a[176:179], v[140:143]
v_add_f32 v20, v20, v65
v_cvt_pk_bf16_f32 v91, v66, v67
s_waitcnt lgkmcnt(2)
v_mfma_f32_16x16x32_bf16 v[24:27], a[196:199], a[100:103], v[24:27]
ds_read_b128 a[192:195], v4 offset:36864
v_add_f32 v20, v20, v66
v_add_f32 v20, v20, v67
v_mfma_f32_16x16x32_bf16 v[28:31], a[196:199], a[116:119], v[28:31]
v_exp_f32 v68, v68
v_mfma_f32_16x16x32_bf16 v[32:35], a[196:199], a[132:135], v[32:35]
v_exp_f32 v69, v69
s_cbranch_vccnz L_thr4
L_thr4_ret:
buffer_load_dwordx4 v2, s[20:23], s60 offen offset:2048 nt lds
v_mfma_f32_16x16x32_bf16 v[36:39], a[196:199], a[148:151], v[36:39]
v_exp_f32 v70, v70
v_mfma_f32_16x16x32_bf16 v[40:43], a[196:199], a[164:167], v[40:43]
v_exp_f32 v71, v71
v_mfma_f32_16x16x32_bf16 v[44:47], a[196:199], a[180:183], v[44:47]
v_add_f32 v21, v21, v68
v_cvt_pk_bf16_f32 v94, v68, v69
s_waitcnt lgkmcnt(2)
v_mfma_f32_16x16x32_bf16 v[24:27], a[200:203], a[104:107], v[24:27]
ds_read_b128 a[196:199], v5 offset:36864
v_add_f32 v21, v21, v69
v_cvt_pk_bf16_f32 v95, v70, v71
v_mfma_f32_16x16x32_bf16 v[28:31], a[200:203], a[120:123], v[28:31]
v_add_f32 v21, v21, v70
v_add_f32 v21, v21, v71
v_mfma_f32_16x16x32_bf16 v[32:35], a[200:203], a[136:139], v[32:35]
v_mfma_f32_16x16x32_bf16 v[36:39], a[200:203], a[152:155], v[36:39]
v_mfma_f32_16x16x32_bf16 v[40:43], a[200:203], a[168:171], v[40:43]
v_mfma_f32_16x16x32_bf16 v[44:47], a[200:203], a[184:187], v[44:47]
s_waitcnt lgkmcnt(2)
v_mfma_f32_16x16x32_bf16 v[24:27], a[204:207], a[108:111], v[24:27]
ds_read_b128 a[200:203], v6 offset:36864
v_mfma_f32_16x16x32_bf16 v[28:31], a[204:207], a[124:127], v[28:31]
v_mfma_f32_16x16x32_bf16 v[32:35], a[204:207], a[140:143], v[32:35]
buffer_load_dwordx4 v3, s[20:23], s60 offen offset:3072 nt lds
v_xor_b32 v4, 0x10000, v4
v_mfma_f32_16x16x32_bf16 v[36:39], a[204:207], a[156:159], v[36:39]
v_xor_b32 v5, 0x10000, v5
v_mfma_f32_16x16x32_bf16 v[40:43], a[204:207], a[172:175], v[40:43]
v_xor_b32 v6, 0x10000, v6
v_mfma_f32_16x16x32_bf16 v[44:47], a[204:207], a[188:191], v[44:47]
s_waitcnt lgkmcnt(2)
v_mfma_f32_16x16x32_bf16 v[48:51], a[192:195], a[96:99], v[120:123]
ds_read_b128 a[204:207], v7 offset:36864
v_mfma_f32_16x16x32_bf16 v[52:55], a[192:195], a[112:115], v[124:127]
v_mfma_f32_16x16x32_bf16 v[56:59], a[192:195], a[128:131], v[128:131]
v_exp_f32 v24, v24
v_mfma_f32_16x16x32_bf16 v[60:63], a[192:195], a[144:147], v[132:135]
v_exp_f32 v25, v25
v_xor_b32 v7, 0x10000, v7
v_mfma_f32_16x16x32_bf16 v[64:67], a[192:195], a[160:163], v[136:139]
v_exp_f32 v26, v26
v_mfma_f32_16x16x32_bf16 v[68:71], a[192:195], a[176:179], v[140:143]
v_exp_f32 v27, v27
s_waitcnt lgkmcnt(2)
v_mfma_f32_16x16x32_bf16 v[48:51], a[196:199], a[100:103], v[48:51]
ds_read_b64_tr_b16 a[192:193], v8 offset:32768
ds_read_b64_tr_b16 a[194:195], v8 offset:36864
v_add_f32 v16, v16, v24
v_cvt_pk_bf16_f32 v96, v24, v25
s_add_u32 m0, s62, 16384
v_mfma_f32_16x16x32_bf16 v[52:55], a[196:199], a[116:119], v[52:55]
v_add_f32 v16, v16, v25
v_cvt_pk_bf16_f32 v97, v26, v27
v_mfma_f32_16x16x32_bf16 v[56:59], a[196:199], a[132:135], v[56:59]
v_add_f32 v16, v16, v26
v_add_f32 v16, v16, v27
s_cbranch_vccnz L_thr5
L_thr5_ret:
buffer_load_dwordx4 v2, s[24:27], s61 offen offset:0 nt lds
v_mfma_f32_16x16x32_bf16 v[60:63], a[196:199], a[148:151], v[60:63]
v_exp_f32 v28, v28
v_mfma_f32_16x16x32_bf16 v[64:67], a[196:199], a[164:167], v[64:67]
v_exp_f32 v29, v29
v_mfma_f32_16x16x32_bf16 v[68:71], a[196:199], a[180:183], v[68:71]
v_exp_f32 v30, v30
s_waitcnt lgkmcnt(3)
v_mfma_f32_16x16x32_bf16 v[48:51], a[200:203], a[104:107], v[48:51]
ds_read_b64_tr_b16 a[196:197], v9 offset:32768
ds_read_b64_tr_b16 a[198:199], v9 offset:36864
v_exp_f32 v31, v31
v_mfma_f32_16x16x32_bf16 v[52:55], a[200:203], a[120:123], v[52:55]
v_add_f32 v17, v17, v28
v_cvt_pk_bf16_f32 v100, v28, v29
v_mfma_f32_16x16x32_bf16 v[56:59], a[200:203], a[136:139], v[56:59]
v_add_f32 v17, v17, v29
v_cvt_pk_bf16_f32 v101, v30, v31
v_mfma_f32_16x16x32_bf16 v[60:63], a[200:203], a[152:155], v[60:63]
v_add_f32 v17, v17, v30
v_add_f32 v17, v17, v31
v_mfma_f32_16x16x32_bf16 v[64:67], a[200:203], a[168:171], v[64:67]
v_exp_f32 v32, v32
v_mfma_f32_16x16x32_bf16 v[68:71], a[200:203], a[184:187], v[68:71]
v_exp_f32 v33, v33
s_waitcnt lgkmcnt(4)
v_mfma_f32_16x16x32_bf16 v[48:51], a[204:207], a[108:111], v[48:51]
ds_read_b64_tr_b16 a[200:201], v10 offset:32768
ds_read_b64_tr_b16 a[202:203], v10 offset:36864
v_exp_f32 v34, v34
v_mfma_f32_16x16x32_bf16 v[52:55], a[204:207], a[124:127], v[52:55]
v_exp_f32 v35, v35
v_mfma_f32_16x16x32_bf16 v[56:59], a[204:207], a[140:143], v[56:59]
v_add_f32 v18, v18, v32
v_cvt_pk_bf16_f32 v104, v32, v33
buffer_load_dwordx4 v3, s[24:27], s61 offen offset:1024 nt lds
v_mfma_f32_16x16x32_bf16 v[60:63], a[204:207], a[156:159], v[60:63]
v_add_f32 v18, v18, v33
v_cvt_pk_bf16_f32 v105, v34, v35
v_mfma_f32_16x16x32_bf16 v[64:67], a[204:207], a[172:175], v[64:67]
v_add_f32 v18, v18, v34
v_add_f32 v18, v18, v35
v_mfma_f32_16x16x32_bf16 v[68:71], a[204:207], a[188:191], v[68:71]
v_exp_f32 v36, v36
s_waitcnt lgkmcnt(4)
v_mfma_f32_16x16x32_bf16 v[144:147], a[192:195], v[72:75], v[144:147]
ds_read_b64_tr_b16 a[204:205], v11 offset:32768
ds_read_b64_tr_b16 a[206:207], v11 offset:36864
v_exp_f32 v37, v37
v_mfma_f32_16x16x32_bf16 v[148:151], a[192:195], v[76:79], v[148:151]
v_exp_f32 v38, v38
v_mfma_f32_16x16x32_bf16 v[152:155], a[192:195], v[80:83], v[152:155]
v_exp_f32 v39, v39
v_mfma_f32_16x16x32_bf16 v[156:159], a[192:195], v[84:87], v[156:159]
v_add_f32 v19, v19, v36
v_cvt_pk_bf16_f32 v108, v36, v37
v_mfma_f32_16x16x32_bf16 v[160:163], a[192:195], v[88:91], v[160:163]
v_add_f32 v19, v19, v37
v_cvt_pk_bf16_f32 v109, v38, v39
v_mfma_f32_16x16x32_bf16 v[164:167], a[192:195], v[92:95], v[164:167]
v_add_f32 v19, v19, v38
v_add_f32 v19, v19, v39
s_waitcnt lgkmcnt(4)
v_mfma_f32_16x16x32_bf16 v[168:171], a[196:199], v[72:75], v[168:171]
ds_read_b64_tr_b16 a[192:193], v12 offset:32768
ds_read_b64_tr_b16 a[194:195], v12 offset:36864
v_exp_f32 v40, v40
v_mfma_f32_16x16x32_bf16 v[172:175], a[196:199], v[76:79], v[172:175]
v_exp_f32 v41, v41
v_mfma_f32_16x16x32_bf16 v[176:179], a[196:199], v[80:83], v[176:179]
v_exp_f32 v42, v42
s_cbranch_vccnz L_thr6
L_thr6_ret:
buffer_load_dwordx4 v2, s[24:27], s61 offen offset:2048 nt lds
v_mfma_f32_16x16x32_bf16 v[180:183], a[196:199], v[84:87], v[180:183]
v_exp_f32 v43, v43
v_mfma_f32_16x16x32_bf16 v[184:187], a[196:199], v[88:91], v[184:187]
v_add_f32 v20, v20, v40
v_cvt_pk_bf16_f32 v112, v40, v41
v_mfma_f32_16x16x32_bf16 v[188:191], a[196:199], v[92:95], v[188:191]
v_add_f32 v20, v20, v41
v_cvt_pk_bf16_f32 v113, v42, v43
s_waitcnt lgkmcnt(4)
v_mfma_f32_16x16x32_bf16 v[192:195], a[200:203], v[72:75], v[192:195]
ds_read_b64_tr_b16 a[196:197], v13 offset:32768
ds_read_b64_tr_b16 a[198:199], v13 offset:36864
v_add_f32 v20, v20, v42
v_add_f32 v20, v20, v43
v_mfma_f32_16x16x32_bf16 v[196:199], a[200:203], v[76:79], v[196:199]
v_exp_f32 v44, v44
v_mfma_f32_16x16x32_bf16 v[200:203], a[200:203], v[80:83], v[200:203]
v_exp_f32 v45, v45
v_mfma_f32_16x16x32_bf16 v[204:207], a[200:203], v[84:87], v[204:207]
v_exp_f32 v46, v46
v_mfma_f32_16x16x32_bf16 v[208:211], a[200:203], v[88:91], v[208:211]
v_exp_f32 v47, v47
v_mfma_f32_16x16x32_bf16 v[212:215], a[200:203], v[92:95], v[212:215]
v_add_f32 v21, v21, v44
v_cvt_pk_bf16_f32 v116, v44, v45
s_waitcnt lgkmcnt(4)
v_mfma_f32_16x16x32_bf16 v[216:219], a[204:207], v[72:75], v[216:219]
ds_read_b64_tr_b16 a[200:201], v14 offset:32768
ds_read_b64_tr_b16 a[202:203], v14 offset:36864
v_add_f32 v21, v21, v45
v_cvt_pk_bf16_f32 v117, v46, v47
v_mfma_f32_16x16x32_bf16 v[220:223], a[204:207], v[76:79], v[220:223]
v_add_f32 v21, v21, v46
v_add_f32 v21, v21, v47
v_mfma_f32_16x16x32_bf16 v[224:227], a[204:207], v[80:83], v[224:227]
v_exp_f32 v48, v48
buffer_load_dwordx4 v3, s[24:27], s61 offen offset:3072 nt lds
v_mfma_f32_16x16x32_bf16 v[228:231], a[204:207], v[84:87], v[228:231]
v_exp_f32 v49, v49
v_mfma_f32_16x16x32_bf16 v[232:235], a[204:207], v[88:91], v[232:235]
v_exp_f32 v50, v50
v_mfma_f32_16x16x32_bf16 v[236:239], a[204:207], v[92:95], v[236:239]
v_exp_f32 v51, v51
s_waitcnt lgkmcnt(4)
v_mfma_f32_16x16x32_bf16 a[0:3], a[192:195], v[72:75], a[0:3]
ds_read_b64_tr_b16 a[204:205], v15 offset:32768
ds_read_b64_tr_b16 a[206:207], v15 offset:36864
v_add_f32 v16, v16, v48
v_cvt_pk_bf16_f32 v98, v48, v49
s_add_u32 s56, s64, s79
v_mfma_f32_16x16x32_bf16 a[4:7], a[192:195], v[76:79], a[4:7]
v_add_f32 v16, v16, v49
v_cvt_pk_bf16_f32 v99, v50, v51
s_and_b32 s56, s56, 31
v_mfma_f32_16x16x32_bf16 a[8:11], a[192:195], v[80:83], a[8:11]
v_add_f32 v16, v16, v50
v_add_f32 v16, v16, v51
s_mov_b32 s61, s60
s_lshl_b32 s60, s56, 13
v_mfma_f32_16x16x32_bf16 a[12:15], a[192:195], v[84:87], a[12:15]
v_exp_f32 v52, v52
s_cmp_lt_u32 s64, 32
s_cselect_b32 s60, s60, s73
v_mfma_f32_16x16x32_bf16 a[16:19], a[192:195], v[88:91], a[16:19]
v_exp_f32 v53, v53
s_add_u32 s64, s64, 1
v_mfma_f32_16x16x32_bf16 a[20:23], a[192:195], v[92:95], a[20:23]
v_exp_f32 v54, v54
s_add_u32 s62, s62, 32768
s_and_b32 s62, s62, 0x1ffff
s_waitcnt lgkmcnt(4)
v_mfma_f32_16x16x32_bf16 a[24:27], a[196:199], v[72:75], a[24:27]
v_exp_f32 v55, v55
v_mfma_f32_16x16x32_bf16 a[28:31], a[196:199], v[76:79], a[28:31]
v_add_f32 v17, v17, v52
v_cvt_pk_bf16_f32 v102, v52, v53
v_mfma_f32_16x16x32_bf16 a[32:35], a[196:199], v[80:83], a[32:35]
v_add_f32 v17, v17, v53
v_cvt_pk_bf16_f32 v103, v54, v55
v_mfma_f32_16x16x32_bf16 a[36:39], a[196:199], v[84:87], a[36:39]
v_add_f32 v17, v17, v54
v_add_f32 v17, v17, v55
s_waitcnt vmcnt(16) lgkmcnt(0)
s_barrier
v_mfma_f32_16x16x32_bf16 a[40:43], a[196:199], v[88:91], a[40:43]
ds_read_b128 a[192:195], v4 offset:0
v_exp_f32 v56, v56
s_mov_b32 m0, s62
v_mfma_f32_16x16x32_bf16 a[44:47], a[196:199], v[92:95], a[44:47]
v_exp_f32 v57, v57
v_mfma_f32_16x16x32_bf16 a[48:51], a[200:203], v[72:75], a[48:51]
ds_read_b128 a[196:199], v5 offset:0
v_exp_f32 v58, v58
s_cbranch_vccnz L_thr7
L_thr7_ret:
buffer_load_dwordx4 v2, s[20:23], s60 offen offset:0 nt lds
v_mfma_f32_16x16x32_bf16 a[52:55], a[200:203], v[76:79], a[52:55]
v_exp_f32 v59, v59
v_mfma_f32_16x16x32_bf16 a[56:59], a[200:203], v[80:83], a[56:59]
v_add_f32 v18, v18, v56
v_cvt_pk_bf16_f32 v106, v56, v57
v_mfma_f32_16x16x32_bf16 a[60:63], a[200:203], v[84:87], a[60:63]
v_add_f32 v18, v18, v57
v_cvt_pk_bf16_f32 v107, v58, v59
v_mfma_f32_16x16x32_bf16 a[64:67], a[200:203], v[88:91], a[64:67]
v_add_f32 v18, v18, v58
v_add_f32 v18, v18, v59
v_mfma_f32_16x16x32_bf16 a[68:71], a[200:203], v[92:95], a[68:71]
v_exp_f32 v60, v60
v_mfma_f32_16x16x32_bf16 a[72:75], a[204:207], v[72:75], a[72:75]
ds_read_b128 a[200:203], v6 offset:0
v_exp_f32 v61, v61
v_mfma_f32_16x16x32_bf16 a[76:79], a[204:207], v[76:79], a[76:79]
v_exp_f32 v62, v62
v_mfma_f32_16x16x32_bf16 a[80:83], a[204:207], v[80:83], a[80:83]
v_exp_f32 v63, v63
buffer_load_dwordx4 v3, s[20:23], s60 offen offset:1024 nt lds
v_mfma_f32_16x16x32_bf16 a[84:87], a[204:207], v[84:87], a[84:87]
v_add_f32 v19, v19, v60
v_cvt_pk_bf16_f32 v110, v60, v61
v_mfma_f32_16x16x32_bf16 a[88:91], a[204:207], v[88:91], a[88:91]
v_add_f32 v19, v19, v61
v_cvt_pk_bf16_f32 v111, v62, v63
v_mfma_f32_16x16x32_bf16 a[92:95], a[204:207], v[92:95], a[92:95]
v_add_f32 v19, v19, v62
v_add_f32 v19, v19, v63
s_cmp_le_u32 s53, 2
s_cbranch_scc1 L_late
L_claim_ret:
s_sub_u32 s53, s53, 1
s_cmp_lg_u32 s53, 0
s_cbranch_scc1 L_loop
s_waitcnt lgkmcnt(2)
v_mfma_f32_16x16x32_bf16 v[24:27], a[192:195], a[96:99], v[120:123]
ds_read_b128 a[204:207], v7 offset:0
v_exp_f32 v64, v64
s_mov_b32 s40, s12
s_mov_b32 s41, s13
v_mfma_f32_16x16x32_bf16 v[28:31], a[192:195], a[112:115], v[124:127]
v_exp_f32 v65, v65
s_mov_b32 s42, 4718592
s_mov_b32 s43, 0x20000
v_mfma_f32_16x16x32_bf16 v[32:35], a[192:195], a[128:131], v[128:131]
v_exp_f32 v66, v66
s_lshr_b32 s54, s2, 3
s_lshl_b32 s54, s54, 2
v_mfma_f32_16x16x32_bf16 v[36:39], a[192:195], a[144:147], v[132:135]
v_exp_f32 v67, v67
s_add_u32 s54, s54, s3
s_mul_i32 s54, s54, 36864
v_mfma_f32_16x16x32_bf16 v[40:43], a[192:195], a[160:163], v[136:139]
v_add_f32 v20, v20, v64
v_cvt_pk_bf16_f32 v114, v64, v65
s_and_b32 s55, s2, 1
s_mul_i32 s55, s55, 512
v_mfma_f32_16x16x32_bf16 v[44:47], a[192:195], a[176:179], v[140:143]
v_add_f32 v20, v20, v65
v_cvt_pk_bf16_f32 v115, v66, v67
s_add_u32 s54, s54, s55
v_and_b32 v244, 31, v1
s_waitcnt lgkmcnt(2)
v_mfma_f32_16x16x32_bf16 v[24:27], a[196:199], a[100:103], v[24:27]
ds_read_b128 a[192:195], v4 offset:4096
v_add_f32 v20, v20, v66
v_add_f32 v20, v20, v67
v_lshrrev_b32 v245, 5, v1
v_mul_u32_u24 v244, 1152, v244
v_mfma_f32_16x16x32_bf16 v[28:31], a[196:199], a[116:119], v[28:31]
v_exp_f32 v68, v68
v_lshl_add_u32 v244, v245, 7, v244
v_add_u32 v244, s54, v244
v_mfma_f32_16x16x32_bf16 v[32:35], a[196:199], a[132:135], v[32:35]
v_exp_f32 v69, v69
v_lshlrev_b32 v245, 30, v245
v_or_b32 v245, v245, v244
v_mfma_f32_16x16x32_bf16 v[36:39], a[196:199], a[148:151], v[36:39]
v_exp_f32 v70, v70
v_mfma_f32_16x16x32_bf16 v[40:43], a[196:199], a[164:167], v[40:43]
v_exp_f32 v71, v71
buffer_load_dword a208, v244, s[40:43], 0 offen offset:0
v_mfma_f32_16x16x32_bf16 v[44:47], a[196:199], a[180:183], v[44:47]
v_add_f32 v21, v21, v68
v_cvt_pk_bf16_f32 v118, v68, v69
s_waitcnt lgkmcnt(2)
v_mfma_f32_16x16x32_bf16 v[24:27], a[200:203], a[104:107], v[24:27]
ds_read_b128 a[196:199], v5 offset:4096
v_add_f32 v21, v21, v69
v_cvt_pk_bf16_f32 v119, v70, v71
v_mfma_f32_16x16x32_bf16 v[28:31], a[200:203], a[120:123], v[28:31]
v_add_f32 v21, v21, v70
v_add_f32 v21, v21, v71
v_mfma_f32_16x16x32_bf16 v[32:35], a[200:203], a[136:139], v[32:35]
v_mfma_f32_16x16x32_bf16 v[36:39], a[200:203], a[152:155], v[36:39]
v_xor_b32 v8, 0x10000, v8
v_mfma_f32_16x16x32_bf16 v[40:43], a[200:203], a[168:171], v[40:43]
v_xor_b32 v9, 0x10000, v9
v_mfma_f32_16x16x32_bf16 v[44:47], a[200:203], a[184:187], v[44:47]
v_xor_b32 v10, 0x10000, v10
s_waitcnt lgkmcnt(2)
v_mfma_f32_16x16x32_bf16 v[24:27], a[204:207], a[108:111], v[24:27]
ds_read_b128 a[200:203], v6 offset:4096
v_xor_b32 v11, 0x10000, v11
v_mfma_f32_16x16x32_bf16 v[28:31], a[204:207], a[124:127], v[28:31]
v_xor_b32 v12, 0x10000, v12
v_mfma_f32_16x16x32_bf16 v[32:35], a[204:207], a[140:143], v[32:35]
v_xor_b32 v13, 0x10000, v13
v_mfma_f32_16x16x32_bf16 v[36:39], a[204:207], a[156:159], v[36:39]
v_xor_b32 v14, 0x10000, v14
v_mfma_f32_16x16x32_bf16 v[40:43], a[204:207], a[172:175], v[40:43]
v_xor_b32 v15, 0x10000, v15
buffer_load_dword a209, v244, s[40:43], 0 offen offset:256
v_mfma_f32_16x16x32_bf16 v[44:47], a[204:207], a[188:191], v[44:47]
s_waitcnt lgkmcnt(2)
v_mfma_f32_16x16x32_bf16 v[48:51], a[192:195], a[96:99], v[120:123]
ds_read_b128 a[204:207], v7 offset:4096
v_mfma_f32_16x16x32_bf16 v[52:55], a[192:195], a[112:115], v[124:127]
v_mfma_f32_16x16x32_bf16 v[56:59], a[192:195], a[128:131], v[128:131]
v_exp_f32 v24, v24
v_mfma_f32_16x16x32_bf16 v[60:63], a[192:195], a[144:147], v[132:135]
v_exp_f32 v25, v25
v_mfma_f32_16x16x32_bf16 v[64:67], a[192:195], a[160:163], v[136:139]
v_exp_f32 v26, v26
v_mfma_f32_16x16x32_bf16 v[68:71], a[192:195], a[176:179], v[140:143]
v_exp_f32 v27, v27
s_waitcnt lgkmcnt(2)
v_mfma_f32_16x16x32_bf16 v[48:51], a[196:199], a[100:103], v[48:51]
ds_read_b64_tr_b16 a[192:193], v8 offset:0
ds_read_b64_tr_b16 a[194:195], v8 offset:4096
v_add_f32 v16, v16, v24
v_cvt_pk_bf16_f32 v72, v24, v25
v_mfma_f32_16x16x32_bf16 v[52:55], a[196:199], a[116:119], v[52:55]
v_add_f32 v16, v16, v25
v_cvt_pk_bf16_f32 v73, v26, v27
v_mfma_f32_16x16x32_bf16 v[56:59], a[196:199], a[132:135], v[56:59]
v_add_f32 v16, v16, v26
v_add_f32 v16, v16, v27
v_mfma_f32_16x16x32_bf16 v[60:63], a[196:199], a[148:151], v[60:63]
v_exp_f32 v28, v28
v_mfma_f32_16x16x32_bf16 v[64:67], a[196:199], a[164:167], v[64:67]
v_exp_f32 v29, v29
buffer_load_dword a210, v245, s[40:43], 0 offen offset:512
v_mfma_f32_16x16x32_bf16 v[68:71], a[196:199], a[180:183], v[68:71]
v_exp_f32 v30, v30
s_waitcnt lgkmcnt(3)
v_mfma_f32_16x16x32_bf16 v[48:51], a[200:203], a[104:107], v[48:51]
ds_read_b64_tr_b16 a[196:197], v9 offset:0
ds_read_b64_tr_b16 a[198:199], v9 offset:4096
v_exp_f32 v31, v31
v_mfma_f32_16x16x32_bf16 v[52:55], a[200:203], a[120:123], v[52:55]
v_add_f32 v17, v17, v28
v_cvt_pk_bf16_f32 v76, v28, v29
v_mfma_f32_16x16x32_bf16 v[56:59], a[200:203], a[136:139], v[56:59]
v_add_f32 v17, v17, v29
v_cvt_pk_bf16_f32 v77, v30, v31
v_mfma_f32_16x16x32_bf16 v[60:63], a[200:203], a[152:155], v[60:63]
v_add_f32 v17, v17, v30
v_add_f32 v17, v17, v31
v_mfma_f32_16x16x32_bf16 v[64:67], a[200:203], a[168:171], v[64:67]
v_exp_f32 v32, v32
v_mfma_f32_16x16x32_bf16 v[68:71], a[200:203], a[184:187], v[68:71]
v_exp_f32 v33, v33
s_waitcnt lgkmcnt(4)
v_mfma_f32_16x16x32_bf16 v[48:51], a[204:207], a[108:111], v[48:51]
ds_read_b64_tr_b16 a[200:201], v10 offset:0
ds_read_b64_tr_b16 a[202:203], v10 offset:4096
v_exp_f32 v34, v34
v_mfma_f32_16x16x32_bf16 v[52:55], a[204:207], a[124:127], v[52:55]
v_exp_f32 v35, v35
v_mfma_f32_16x16x32_bf16 v[56:59], a[204:207], a[140:143], v[56:59]
v_add_f32 v18, v18, v32
v_cvt_pk_bf16_f32 v80, v32, v33
v_mfma_f32_16x16x32_bf16 v[60:63], a[204:207], a[156:159], v[60:63]
v_add_f32 v18, v18, v33
v_cvt_pk_bf16_f32 v81, v34, v35
v_mfma_f32_16x16x32_bf16 v[64:67], a[204:207], a[172:175], v[64:67]
v_add_f32 v18, v18, v34
v_add_f32 v18, v18, v35
v_mfma_f32_16x16x32_bf16 v[68:71], a[204:207], a[188:191], v[68:71]
v_exp_f32 v36, v36
s_waitcnt lgkmcnt(4)
v_mfma_f32_16x16x32_bf16 v[144:147], a[192:195], v[96:99], v[144:147]
ds_read_b64_tr_b16 a[204:205], v11 offset:0
ds_read_b64_tr_b16 a[206:207], v11 offset:4096
v_exp_f32 v37, v37
v_mfma_f32_16x16x32_bf16 v[148:151], a[192:195], v[100:103], v[148:151]
v_exp_f32 v38, v38
v_mfma_f32_16x16x32_bf16 v[152:155], a[192:195], v[104:107], v[152:155]
v_exp_f32 v39, v39
v_mfma_f32_16x16x32_bf16 v[156:159], a[192:195], v[108:111], v[156:159]
v_add_f32 v19, v19, v36
v_cvt_pk_bf16_f32 v84, v36, v37
v_mfma_f32_16x16x32_bf16 v[160:163], a[192:195], v[112:115], v[160:163]
v_add_f32 v19, v19, v37
v_cvt_pk_bf16_f32 v85, v38, v39
v_mfma_f32_16x16x32_bf16 v[164:167], a[192:195], v[116:119], v[164:167]
v_add_f32 v19, v19, v38
v_add_f32 v19, v19, v39
s_waitcnt lgkmcnt(4)
v_mfma_f32_16x16x32_bf16 v[168:171], a[196:199], v[96:99], v[168:171]
ds_read_b64_tr_b16 a[192:193], v12 offset:0
ds_read_b64_tr_b16 a[194:195], v12 offset:4096
v_exp_f32 v40, v40
v_mfma_f32_16x16x32_bf16 v[172:175], a[196:199], v[100:103], v[172:175]
v_exp_f32 v41, v41
v_mfma_f32_16x16x32_bf16 v[176:179], a[196:199], v[104:107], v[176:179]
v_exp_f32 v42, v42
v_mfma_f32_16x16x32_bf16 v[180:183], a[196:199], v[108:111], v[180:183]
v_exp_f32 v43, v43
v_mfma_f32_16x16x32_bf16 v[184:187], a[196:199], v[112:115], v[184:187]
v_add_f32 v20, v20, v40
v_cvt_pk_bf16_f32 v88, v40, v41
v_mfma_f32_16x16x32_bf16 v[188:191], a[196:199], v[116:119], v[188:191]
v_add_f32 v20, v20, v41
v_cvt_pk_bf16_f32 v89, v42, v43
s_waitcnt lgkmcnt(4)
v_mfma_f32_16x16x32_bf16 v[192:195], a[200:203], v[96:99], v[192:195]
ds_read_b64_tr_b16 a[196:197], v13 offset:0
ds_read_b64_tr_b16 a[198:199], v13 offset:4096
v_add_f32 v20, v20, v42
v_add_f32 v20, v20, v43
v_mfma_f32_16x16x32_bf16 v[196:199], a[200:203], v[100:103], v[196:199]
v_exp_f32 v44, v44
v_mfma_f32_16x16x32_bf16 v[200:203], a[200:203], v[104:107], v[200:203]
v_exp_f32 v45, v45
v_mfma_f32_16x16x32_bf16 v[204:207], a[200:203], v[108:111], v[204:207]
v_exp_f32 v46, v46
v_mfma_f32_16x16x32_bf16 v[208:211], a[200:203], v[112:115], v[208:211]
v_exp_f32 v47, v47
v_mfma_f32_16x16x32_bf16 v[212:215], a[200:203], v[116:119], v[212:215]
v_add_f32 v21, v21, v44
v_cvt_pk_bf16_f32 v92, v44, v45
s_waitcnt lgkmcnt(4)
v_mfma_f32_16x16x32_bf16 v[216:219], a[204:207], v[96:99], v[216:219]
ds_read_b64_tr_b16 a[200:201], v14 offset:0
ds_read_b64_tr_b16 a[202:203], v14 offset:4096
v_add_f32 v21, v21, v45
v_cvt_pk_bf16_f32 v93, v46, v47
v_mfma_f32_16x16x32_bf16 v[220:223], a[204:207], v[100:103], v[220:223]
v_add_f32 v21, v21, v46
v_add_f32 v21, v21, v47
v_mfma_f32_16x16x32_bf16 v[224:227], a[204:207], v[104:107], v[224:227]
v_exp_f32 v48, v48
v_mfma_f32_16x16x32_bf16 v[228:231], a[204:207], v[108:111], v[228:231]
v_exp_f32 v49, v49
v_mfma_f32_16x16x32_bf16 v[232:235], a[204:207], v[112:115], v[232:235]
v_exp_f32 v50, v50
v_mfma_f32_16x16x32_bf16 v[236:239], a[204:207], v[116:119], v[236:239]
v_exp_f32 v51, v51
s_waitcnt lgkmcnt(4)
v_mfma_f32_16x16x32_bf16 a[0:3], a[192:195], v[96:99], a[0:3]
ds_read_b64_tr_b16 a[204:205], v15 offset:0
ds_read_b64_tr_b16 a[206:207], v15 offset:4096
v_add_f32 v16, v16, v48
v_cvt_pk_bf16_f32 v74, v48, v49
v_mfma_f32_16x16x32_bf16 a[4:7], a[192:195], v[100:103], a[4:7]
v_add_f32 v16, v16, v49
v_cvt_pk_bf16_f32 v75, v50, v51
v_mfma_f32_16x16x32_bf16 a[8:11], a[192:195], v[104:107], a[8:11]
v_add_f32 v16, v16, v50
v_add_f32 v16, v16, v51
v_mfma_f32_16x16x32_bf16 a[12:15], a[192:195], v[108:111], a[12:15]
v_exp_f32 v52, v52
v_mfma_f32_16x16x32_bf16 a[16:19], a[192:195], v[112:115], a[16:19]
v_exp_f32 v53, v53
v_mfma_f32_16x16x32_bf16 a[20:23], a[192:195], v[116:119], a[20:23]
v_exp_f32 v54, v54
s_waitcnt lgkmcnt(4)
v_mfma_f32_16x16x32_bf16 a[24:27], a[196:199], v[96:99], a[24:27]
v_exp_f32 v55, v55
v_mfma_f32_16x16x32_bf16 a[28:31], a[196:199], v[100:103], a[28:31]
v_add_f32 v17, v17, v52
v_cvt_pk_bf16_f32 v78, v52, v53
v_mfma_f32_16x16x32_bf16 a[32:35], a[196:199], v[104:107], a[32:35]
v_add_f32 v17, v17, v53
v_cvt_pk_bf16_f32 v79, v54, v55
v_mfma_f32_16x16x32_bf16 a[36:39], a[196:199], v[108:111], a[36:39]
v_add_f32 v17, v17, v54
v_add_f32 v17, v17, v55
s_waitcnt vmcnt(13) lgkmcnt(0)
s_barrier
v_mfma_f32_16x16x32_bf16 a[40:43], a[196:199], v[112:115], a[40:43]
ds_read_b128 a[192:195], v4 offset:32768
v_exp_f32 v56, v56
v_mfma_f32_16x16x32_bf16 a[44:47], a[196:199], v[116:119], a[44:47]
v_exp_f32 v57, v57
v_mfma_f32_16x16x32_bf16 a[48:51], a[200:203], v[96:99], a[48:51]
ds_read_b128 a[196:199], v5 offset:32768
v_exp_f32 v58, v58
v_mfma_f32_16x16x32_bf16 a[52:55], a[200:203], v[100:103], a[52:55]
v_exp_f32 v59, v59
v_mfma_f32_16x16x32_bf16 a[56:59], a[200:203], v[104:107], a[56:59]
v_add_f32 v18, v18, v56
v_cvt_pk_bf16_f32 v82, v56, v57
v_mfma_f32_16x16x32_bf16 a[60:63], a[200:203], v[108:111], a[60:63]
v_add_f32 v18, v18, v57
v_cvt_pk_bf16_f32 v83, v58, v59
v_mfma_f32_16x16x32_bf16 a[64:67], a[200:203], v[112:115], a[64:67]
v_add_f32 v18, v18, v58
v_add_f32 v18, v18, v59
v_mfma_f32_16x16x32_bf16 a[68:71], a[200:203], v[116:119], a[68:71]
v_exp_f32 v60, v60
v_mfma_f32_16x16x32_bf16 a[72:75], a[204:207], v[96:99], a[72:75]
ds_read_b128 a[200:203], v6 offset:32768
v_exp_f32 v61, v61
v_mfma_f32_16x16x32_bf16 a[76:79], a[204:207], v[100:103], a[76:79]
v_exp_f32 v62, v62
v_mfma_f32_16x16x32_bf16 a[80:83], a[204:207], v[104:107], a[80:83]
v_exp_f32 v63, v63
v_mfma_f32_16x16x32_bf16 a[84:87], a[204:207], v[108:111], a[84:87]
v_add_f32 v19, v19, v60
v_cvt_pk_bf16_f32 v86, v60, v61
v_mfma_f32_16x16x32_bf16 a[88:91], a[204:207], v[112:115], a[88:91]
v_add_f32 v19, v19, v61
v_cvt_pk_bf16_f32 v87, v62, v63
v_mfma_f32_16x16x32_bf16 a[92:95], a[204:207], v[116:119], a[92:95]
v_add_f32 v19, v19, v62
v_add_f32 v19, v19, v63
s_waitcnt lgkmcnt(2)
v_mfma_f32_16x16x32_bf16 v[24:27], a[192:195], a[96:99], v[120:123]
ds_read_b128 a[204:207], v7 offset:32768
v_exp_f32 v64, v64
v_mfma_f32_16x16x32_bf16 v[28:31], a[192:195], a[112:115], v[124:127]
v_exp_f32 v65, v65
v_mfma_f32_16x16x32_bf16 v[32:35], a[192:195], a[128:131], v[128:131]
v_exp_f32 v66, v66
v_mfma_f32_16x16x32_bf16 v[36:39], a[192:195], a[144:147], v[132:135]
v_exp_f32 v67, v67
v_mfma_f32_16x16x32_bf16 v[40:43], a[192:195], a[160:163], v[136:139]
v_add_f32 v20, v20, v64
v_cvt_pk_bf16_f32 v90, v64, v65
v_mfma_f32_16x16x32_bf16 v[44:47], a[192:195], a[176:179], v[140:143]
v_add_f32 v20, v20, v65
v_cvt_pk_bf16_f32 v91, v66, v67
s_waitcnt lgkmcnt(2)
v_mfma_f32_16x16x32_bf16 v[24:27], a[196:199], a[100:103], v[24:27]
ds_read_b128 a[192:195], v4 offset:36864
v_add_f32 v20, v20, v66
v_add_f32 v20, v20, v67
v_mfma_f32_16x16x32_bf16 v[28:31], a[196:199], a[116:119], v[28:31]
v_exp_f32 v68, v68
v_mfma_f32_16x16x32_bf16 v[32:35], a[196:199], a[132:135], v[32:35]
v_exp_f32 v69, v69
v_mfma_f32_16x16x32_bf16 v[36:39], a[196:199], a[148:151], v[36:39]
v_exp_f32 v70, v70
v_mfma_f32_16x16x32_bf16 v[40:43], a[196:199], a[164:167], v[40:43]
v_exp_f32 v71, v71
v_mfma_f32_16x16x32_bf16 v[44:47], a[196:199], a[180:183], v[44:47]
v_add_f32 v21, v21, v68
v_cvt_pk_bf16_f32 v94, v68, v69
s_waitcnt lgkmcnt(2)
v_mfma_f32_16x16x32_bf16 v[24:27], a[200:203], a[104:107], v[24:27]
ds_read_b128 a[196:199], v5 offset:36864
v_add_f32 v21, v21, v69
v_cvt_pk_bf16_f32 v95, v70, v71
v_mfma_f32_16x16x32_bf16 v[28:31], a[200:203], a[120:123], v[28:31]
v_add_f32 v21, v21, v70
v_add_f32 v21, v21, v71
v_mfma_f32_16x16x32_bf16 v[32:35], a[200:203], a[136:139], v[32:35]
v_mfma_f32_16x16x32_bf16 v[36:39], a[200:203], a[152:155], v[36:39]
v_mfma_f32_16x16x32_bf16 v[40:43], a[200:203], a[168:171], v[40:43]
v_mfma_f32_16x16x32_bf16 v[44:47], a[200:203], a[184:187], v[44:47]
s_waitcnt lgkmcnt(2)
v_mfma_f32_16x16x32_bf16 v[24:27], a[204:207], a[108:111], v[24:27]
ds_read_b128 a[200:203], v6 offset:36864
v_mfma_f32_16x16x32_bf16 v[28:31], a[204:207], a[124:127], v[28:31]
v_mfma_f32_16x16x32_bf16 v[32:35], a[204:207], a[140:143], v[32:35]
v_xor_b32 v4, 0x10000, v4
v_mfma_f32_16x16x32_bf16 v[36:39], a[204:207], a[156:159], v[36:39]
v_xor_b32 v5, 0x10000, v5
v_mfma_f32_16x16x32_bf16 v[40:43], a[204:207], a[172:175], v[40:43]
v_xor_b32 v6, 0x10000, v6
v_mfma_f32_16x16x32_bf16 v[44:47], a[204:207], a[188:191], v[44:47]
s_waitcnt lgkmcnt(2)
v_mfma_f32_16x16x32_bf16 v[48:51], a[192:195], a[96:99], v[120:123]
ds_read_b128 a[204:207], v7 offset:36864
v_mfma_f32_16x16x32_bf16 v[52:55], a[192:195], a[112:115], v[124:127]
v_mfma_f32_16x16x32_bf16 v[56:59], a[192:195], a[128:131], v[128:131]
v_exp_f32 v24, v24
v_mfma_f32_16x16x32_bf16 v[60:63], a[192:195], a[144:147], v[132:135]
v_exp_f32 v25, v25
v_xor_b32 v7, 0x10000, v7
v_mfma_f32_16x16x32_bf16 v[64:67], a[192:195], a[160:163], v[136:139]
v_exp_f32 v26, v26
v_mfma_f32_16x16x32_bf16 v[68:71], a[192:195], a[176:179], v[140:143]
v_exp_f32 v27, v27
s_waitcnt lgkmcnt(2)
v_mfma_f32_16x16x32_bf16 v[48:51], a[196:199], a[100:103], v[48:51]
ds_read_b64_tr_b16 a[192:193], v8 offset:32768
ds_read_b64_tr_b16 a[194:195], v8 offset:36864
v_add_f32 v16, v16, v24
v_cvt_pk_bf16_f32 v96, v24, v25
v_mfma_f32_16x16x32_bf16 v[52:55], a[196:199], a[116:119], v[52:55]
v_add_f32 v16, v16, v25
v_cvt_pk_bf16_f32 v97, v26, v27
v_mfma_f32_16x16x32_bf16 v[56:59], a[196:199], a[132:135], v[56:59]
v_add_f32 v16, v16, v26
v_add_f32 v16, v16, v27
v_mfma_f32_16x16x32_bf16 v[60:63], a[196:199], a[148:151], v[60:63]
v_exp_f32 v28, v28
v_mfma_f32_16x16x32_bf16 v[64:67], a[196:199], a[164:167], v[64:67]
v_exp_f32 v29, v29
v_mfma_f32_16x16x32_bf16 v[68:71], a[196:199], a[180:183], v[68:71]
v_exp_f32 v30, v30
s_waitcnt lgkmcnt(3)
v_mfma_f32_16x16x32_bf16 v[48:51], a[200:203], a[104:107], v[48:51]
ds_read_b64_tr_b16 a[196:197], v9 offset:32768
ds_read_b64_tr_b16 a[198:199], v9 offset:36864
v_exp_f32 v31, v31
v_mfma_f32_16x16x32_bf16 v[52:55], a[200:203], a[120:123], v[52:55]
v_add_f32 v17, v17, v28
v_cvt_pk_bf16_f32 v100, v28, v29
v_mfma_f32_16x16x32_bf16 v[56:59], a[200:203], a[136:139], v[56:59]
v_add_f32 v17, v17, v29
v_cvt_pk_bf16_f32 v101, v30, v31
v_mfma_f32_16x16x32_bf16 v[60:63], a[200:203], a[152:155], v[60:63]
v_add_f32 v17, v17, v30
v_add_f32 v17, v17, v31
v_mfma_f32_16x16x32_bf16 v[64:67], a[200:203], a[168:171], v[64:67]
v_exp_f32 v32, v32
ds_write_b32 v23, v22
v_mfma_f32_16x16x32_bf16 v[68:71], a[200:203], a[184:187], v[68:71]
v_exp_f32 v33, v33
s_waitcnt lgkmcnt(4)
v_mfma_f32_16x16x32_bf16 v[48:51], a[204:207], a[108:111], v[48:51]
ds_read_b64_tr_b16 a[200:201], v10 offset:32768
ds_read_b64_tr_b16 a[202:203], v10 offset:36864
v_exp_f32 v34, v34
v_mfma_f32_16x16x32_bf16 v[52:55], a[204:207], a[124:127], v[52:55]
v_exp_f32 v35, v35
v_mfma_f32_16x16x32_bf16 v[56:59], a[204:207], a[140:143], v[56:59]
v_add_f32 v18, v18, v32
v_cvt_pk_bf16_f32 v104, v32, v33
v_mfma_f32_16x16x32_bf16 v[60:63], a[204:207], a[156:159], v[60:63]
v_add_f32 v18, v18, v33
v_cvt_pk_bf16_f32 v105, v34, v35
v_mfma_f32_16x16x32_bf16 v[64:67], a[204:207], a[172:175], v[64:67]
v_add_f32 v18, v18, v34
v_add_f32 v18, v18, v35
v_mfma_f32_16x16x32_bf16 v[68:71], a[204:207], a[188:191], v[68:71]
v_exp_f32 v36, v36
s_waitcnt lgkmcnt(4)
v_mfma_f32_16x16x32_bf16 v[144:147], a[192:195], v[72:75], v[144:147]
ds_read_b64_tr_b16 a[204:205], v11 offset:32768
ds_read_b64_tr_b16 a[206:207], v11 offset:36864
v_exp_f32 v37, v37
v_mfma_f32_16x16x32_bf16 v[148:151], a[192:195], v[76:79], v[148:151]
v_exp_f32 v38, v38
v_mfma_f32_16x16x32_bf16 v[152:155], a[192:195], v[80:83], v[152:155]
v_exp_f32 v39, v39
v_mfma_f32_16x16x32_bf16 v[156:159], a[192:195], v[84:87], v[156:159]
v_add_f32 v19, v19, v36
v_cvt_pk_bf16_f32 v108, v36, v37
v_mfma_f32_16x16x32_bf16 v[160:163], a[192:195], v[88:91], v[160:163]
v_add_f32 v19, v19, v37
v_cvt_pk_bf16_f32 v109, v38, v39
v_mfma_f32_16x16x32_bf16 v[164:167], a[192:195], v[92:95], v[164:167]
v_add_f32 v19, v19, v38
v_add_f32 v19, v19, v39
s_waitcnt lgkmcnt(4)
v_mfma_f32_16x16x32_bf16 v[168:171], a[196:199], v[72:75], v[168:171]
ds_read_b64_tr_b16 a[192:193], v12 offset:32768
ds_read_b64_tr_b16 a[194:195], v12 offset:36864
v_exp_f32 v40, v40
v_mfma_f32_16x16x32_bf16 v[172:175], a[196:199], v[76:79], v[172:175]
v_exp_f32 v41, v41
v_mfma_f32_16x16x32_bf16 v[176:179], a[196:199], v[80:83], v[176:179]
v_exp_f32 v42, v42
v_mfma_f32_16x16x32_bf16 v[180:183], a[196:199], v[84:87], v[180:183]
v_exp_f32 v43, v43
v_mfma_f32_16x16x32_bf16 v[184:187], a[196:199], v[88:91], v[184:187]
v_add_f32 v20, v20, v40
v_cvt_pk_bf16_f32 v112, v40, v41
v_mfma_f32_16x16x32_bf16 v[188:191], a[196:199], v[92:95], v[188:191]
v_add_f32 v20, v20, v41
v_cvt_pk_bf16_f32 v113, v42, v43
s_waitcnt lgkmcnt(4)
v_mfma_f32_16x16x32_bf16 v[192:195], a[200:203], v[72:75], v[192:195]
ds_read_b64_tr_b16 a[196:197], v13 offset:32768
ds_read_b64_tr_b16 a[198:199], v13 offset:36864
v_add_f32 v20, v20, v42
v_add_f32 v20, v20, v43
v_mfma_f32_16x16x32_bf16 v[196:199], a[200:203], v[76:79], v[196:199]
v_exp_f32 v44, v44
v_mfma_f32_16x16x32_bf16 v[200:203], a[200:203], v[80:83], v[200:203]
v_exp_f32 v45, v45
v_mfma_f32_16x16x32_bf16 v[204:207], a[200:203], v[84:87], v[204:207]
v_exp_f32 v46, v46
v_mfma_f32_16x16x32_bf16 v[208:211], a[200:203], v[88:91], v[208:211]
v_exp_f32 v47, v47
v_mfma_f32_16x16x32_bf16 v[212:215], a[200:203], v[92:95], v[212:215]
v_add_f32 v21, v21, v44
v_cvt_pk_bf16_f32 v116, v44, v45
s_waitcnt lgkmcnt(4)
v_mfma_f32_16x16x32_bf16 v[216:219], a[204:207], v[72:75], v[216:219]
ds_read_b64_tr_b16 a[200:201], v14 offset:32768
ds_read_b64_tr_b16 a[202:203], v14 offset:36864
v_add_f32 v21, v21, v45
v_cvt_pk_bf16_f32 v117, v46, v47
v_mfma_f32_16x16x32_bf16 v[220:223], a[204:207], v[76:79], v[220:223]
v_add_f32 v21, v21, v46
v_add_f32 v21, v21, v47
v_mfma_f32_16x16x32_bf16 v[224:227], a[204:207], v[80:83], v[224:227]
v_exp_f32 v48, v48
v_mfma_f32_16x16x32_bf16 v[228:231], a[204:207], v[84:87], v[228:231]
v_exp_f32 v49, v49
v_mfma_f32_16x16x32_bf16 v[232:235], a[204:207], v[88:91], v[232:235]
v_exp_f32 v50, v50
v_mfma_f32_16x16x32_bf16 v[236:239], a[204:207], v[92:95], v[236:239]
v_exp_f32 v51, v51
s_waitcnt lgkmcnt(4)
v_mfma_f32_16x16x32_bf16 a[0:3], a[192:195], v[72:75], a[0:3]
ds_read_b64_tr_b16 a[204:205], v15 offset:32768
ds_read_b64_tr_b16 a[206:207], v15 offset:36864
v_add_f32 v16, v16, v48
v_cvt_pk_bf16_f32 v98, v48, v49
v_mfma_f32_16x16x32_bf16 a[4:7], a[192:195], v[76:79], a[4:7]
v_add_f32 v16, v16, v49
v_cvt_pk_bf16_f32 v99, v50, v51
v_mfma_f32_16x16x32_bf16 a[8:11], a[192:195], v[80:83], a[8:11]
v_add_f32 v16, v16, v50
v_add_f32 v16, v16, v51
v_mfma_f32_16x16x32_bf16 a[12:15], a[192:195], v[84:87], a[12:15]
v_exp_f32 v52, v52
v_mfma_f32_16x16x32_bf16 a[16:19], a[192:195], v[88:91], a[16:19]
v_exp_f32 v53, v53
v_mfma_f32_16x16x32_bf16 a[20:23], a[192:195], v[92:95], a[20:23]
v_exp_f32 v54, v54
s_waitcnt lgkmcnt(4)
v_mfma_f32_16x16x32_bf16 a[24:27], a[196:199], v[72:75], a[24:27]
v_exp_f32 v55, v55
v_mfma_f32_16x16x32_bf16 a[28:31], a[196:199], v[76:79], a[28:31]
v_add_f32 v17, v17, v52
v_cvt_pk_bf16_f32 v102, v52, v53
v_mfma_f32_16x16x32_bf16 a[32:35], a[196:199], v[80:83], a[32:35]
v_add_f32 v17, v17, v53
v_cvt_pk_bf16_f32 v103, v54, v55
v_mfma_f32_16x16x32_bf16 a[36:39], a[196:199], v[84:87], a[36:39]
v_add_f32 v17, v17, v54
v_add_f32 v17, v17, v55
s_waitcnt vmcnt(5) lgkmcnt(0)
s_barrier
v_mfma_f32_16x16x32_bf16 a[40:43], a[196:199], v[88:91], a[40:43]
v_exp_f32 v56, v56
v_mfma_f32_16x16x32_bf16 a[44:47], a[196:199], v[92:95], a[44:47]
v_exp_f32 v57, v57
v_mfma_f32_16x16x32_bf16 a[48:51], a[200:203], v[72:75], a[48:51]
v_exp_f32 v58, v58
v_mfma_f32_16x16x32_bf16 a[52:55], a[200:203], v[76:79], a[52:55]
v_exp_f32 v59, v59
v_mfma_f32_16x16x32_bf16 a[56:59], a[200:203], v[80:83], a[56:59]
v_add_f32 v18, v18, v56
v_cvt_pk_bf16_f32 v106, v56, v57
v_mfma_f32_16x16x32_bf16 a[60:63], a[200:203], v[84:87], a[60:63]
v_add_f32 v18, v18, v57
v_cvt_pk_bf16_f32 v107, v58, v59
v_mfma_f32_16x16x32_bf16 a[64:67], a[200:203], v[88:91], a[64:67]
v_add_f32 v18, v18, v58
v_add_f32 v18, v18, v59
v_mfma_f32_16x16x32_bf16 a[68:71], a[200:203], v[92:95], a[68:71]
v_exp_f32 v60, v60
v_mfma_f32_16x16x32_bf16 a[72:75], a[204:207], v[72:75], a[72:75]
v_exp_f32 v61, v61
v_mfma_f32_16x16x32_bf16 a[76:79], a[204:207], v[76:79], a[76:79]
v_exp_f32 v62, v62
v_mfma_f32_16x16x32_bf16 a[80:83], a[204:207], v[80:83], a[80:83]
v_exp_f32 v63, v63
v_mfma_f32_16x16x32_bf16 a[84:87], a[204:207], v[84:87], a[84:87]
v_add_f32 v19, v19, v60
v_cvt_pk_bf16_f32 v110, v60, v61
v_mfma_f32_16x16x32_bf16 a[88:91], a[204:207], v[88:91], a[88:91]
v_add_f32 v19, v19, v61
v_cvt_pk_bf16_f32 v111, v62, v63
v_mfma_f32_16x16x32_bf16 a[92:95], a[204:207], v[92:95], a[92:95]
v_add_f32 v19, v19, v62
v_add_f32 v19, v19, v63
s_waitcnt lgkmcnt(0)
v_mov_b32 v240, 150528
ds_read_b32 v240, v240
v_exp_f32 v64, v64
v_exp_f32 v65, v65
v_exp_f32 v66, v66
v_exp_f32 v67, v67
v_add_f32 v20, v20, v64
v_cvt_pk_bf16_f32 v114, v64, v65
v_add_f32 v20, v20, v65
v_cvt_pk_bf16_f32 v115, v66, v67
v_add_f32 v20, v20, v66
v_add_f32 v20, v20, v67
v_exp_f32 v68, v68
v_exp_f32 v69, v69
v_exp_f32 v70, v70
v_exp_f32 v71, v71
v_add_f32 v21, v21, v68
v_cvt_pk_bf16_f32 v118, v68, v69
v_add_f32 v21, v21, v69
v_cvt_pk_bf16_f32 v119, v70, v71
v_add_f32 v21, v21, v70
v_add_f32 v21, v21, v71
v_xor_b32 v8, 0x10000, v8
v_xor_b32 v9, 0x10000, v9
v_xor_b32 v10, 0x10000, v10
v_xor_b32 v11, 0x10000, v11
v_xor_b32 v12, 0x10000, v12
v_xor_b32 v13, 0x10000, v13
v_xor_b32 v14, 0x10000, v14
v_xor_b32 v15, 0x10000, v15
ds_read_b64_tr_b16 a[192:193], v8 offset:0
ds_read_b64_tr_b16 a[194:195], v8 offset:4096
ds_read_b64_tr_b16 a[196:197], v9 offset:0
ds_read_b64_tr_b16 a[198:199], v9 offset:4096
ds_read_b64_tr_b16 a[200:201], v10 offset:0
ds_read_b64_tr_b16 a[202:203], v10 offset:4096
s_waitcnt lgkmcnt(4)
v_mfma_f32_16x16x32_bf16 v[144:147], a[192:195], v[96:99], v[144:147]
ds_read_b64_tr_b16 a[204:205], v11 offset:0
ds_read_b64_tr_b16 a[206:207], v11 offset:4096
v_readfirstlane_b32 s54, v240
s_cmp_eq_u32 s65, 0
s_nop 0
v_mfma_f32_16x16x32_bf16 v[148:151], a[192:195], v[100:103], v[148:151]
s_nop 0
s_nop 0
s_cselect_b32 s78, s54, s78
v_mfma_f32_16x16x32_bf16 v[152:155], a[192:195], v[104:107], v[152:155]
s_add_u32 s54, s78, 24
s_sub_u32 s55, s78, 3
v_mfma_f32_16x16x32_bf16 v[156:159], a[192:195], v[108:111], v[156:159]
s_cmp_lt_u32 s78, 3
s_cselect_b32 s54, s54, s55
s_cmp_lt_u32 s78, 27
v_mfma_f32_16x16x32_bf16 v[160:163], a[192:195], v[112:115], v[160:163]
s_cselect_b32 s69, s54, s78
s_mul_i32 s71, s69, 43
v_mfma_f32_16x16x32_bf16 v[164:167], a[192:195], v[116:119], v[164:167]
s_lshr_b32 s71, s71, 8
s_mul_i32 s54, s71, 6
s_sub_u32 s54, s69, s54
s_waitcnt lgkmcnt(4)
v_mfma_f32_16x16x32_bf16 v[168:171], a[196:199], v[96:99], v[168:171]
ds_read_b64_tr_b16 a[192:193], v12 offset:0
ds_read_b64_tr_b16 a[194:195], v12 offset:4096
s_and_b32 s55, s2, 1
s_mul_i32 s56, s55, 3
v_mfma_f32_16x16x32_bf16 v[172:175], a[196:199], v[100:103], v[172:175]
s_mul_i32 s55, s55, 5
s_cmp_ge_u32 s71, 4
s_cselect_b32 s56, s56, 0
v_mfma_f32_16x16x32_bf16 v[176:179], a[196:199], v[104:107], v[176:179]
s_cselect_b32 s55, 0, s55
s_add_u32 s54, s54, s56
v_mfma_f32_16x16x32_bf16 v[180:183], a[196:199], v[108:111], v[180:183]
s_min_u32 s54, s54, 5
s_min_u32 s71, s71, 4
s_mul_i32 s56, s71, 13
v_mfma_f32_16x16x32_bf16 v[184:187], a[196:199], v[112:115], v[184:187]
s_add_u32 s56, s56, 4
s_lshr_b32 s56, s56, 3
v_mfma_f32_16x16x32_bf16 v[188:191], a[196:199], v[116:119], v[188:191]
s_add_u32 s71, s71, s55
s_cmp_ge_u32 s54, 3
s_cselect_b32 s55, 1, 0
s_waitcnt lgkmcnt(4)
v_mfma_f32_16x16x32_bf16 v[192:195], a[200:203], v[96:99], v[192:195]
ds_read_b64_tr_b16 a[196:197], v13 offset:0
ds_read_b64_tr_b16 a[198:199], v13 offset:4096
s_and_b32 s68, s2, 6
s_add_u32 s68, s68, s55
v_mfma_f32_16x16x32_bf16 v[196:199], a[200:203], v[100:103], v[196:199]
s_mul_i32 s55, s55, 3
s_sub_u32 s70, s54, s55
s_mul_i32 s54, s54, 43
v_mfma_f32_16x16x32_bf16 v[200:203], a[200:203], v[104:107], v[200:203]
s_add_u32 s54, s54, 16
s_lshr_b32 s54, s54, 5
v_mfma_f32_16x16x32_bf16 v[204:207], a[200:203], v[108:111], v[204:207]
s_add_u32 s54, s54, s56
s_and_b32 s54, s54, 7
s_lshl_b32 s75, s3, 12
v_mfma_f32_16x16x32_bf16 v[208:211], a[200:203], v[112:115], v[208:211]
s_mul_i32 s72, s54, 147456
s_lshl_b32 s74, s54, 12
v_mfma_f32_16x16x32_bf16 v[212:215], a[200:203], v[116:119], v[212:215]
s_mov_b32 s40, s12
s_mov_b32 s41, s13
s_cmp_lt_u32 s69, 27
s_waitcnt lgkmcnt(4)
v_mfma_f32_16x16x32_bf16 v[216:219], a[204:207], v[96:99], v[216:219]
ds_read_b64_tr_b16 a[200:201], v14 offset:0
ds_read_b64_tr_b16 a[202:203], v14 offset:4096
s_cselect_b32 s42, 4718592, 0
s_mov_b32 s43, 0x20000
v_mfma_f32_16x16x32_bf16 v[220:223], a[204:207], v[100:103], v[220:223]
v_lshrrev_b32 v240, 4, v1
v_bfe_u32 v241, v1, 2, 2
v_mfma_f32_16x16x32_bf16 v[224:227], a[204:207], v[104:107], v[224:227]
v_and_b32 v242, 3, v1
v_lshrrev_b32 v243, 3, v1
v_mul_u32_u24 v243, 1152, v243
v_mfma_f32_16x16x32_bf16 v[228:231], a[204:207], v[108:111], v[228:231]
v_and_b32 v244, 7, v1
v_lshlrev_b32 v120, 1, v240
v_mfma_f32_16x16x32_bf16 v[232:235], a[204:207], v[112:115], v[232:235]
v_xor_b32 v244, v244, v120
v_lshl_add_u32 v120, v244, 4, v243
s_mul_i32 s54, s3, 1179648
v_mfma_f32_16x16x32_bf16 v[236:239], a[204:207], v[116:119], v[236:239]
s_lshl_b32 s55, s71, 7
s_add_u32 s54, s54, s55
s_waitcnt lgkmcnt(4)
v_mfma_f32_16x16x32_bf16 a[0:3], a[192:195], v[96:99], a[0:3]
ds_read_b64_tr_b16 a[204:205], v15 offset:0
ds_read_b64_tr_b16 a[206:207], v15 offset:4096
v_add_u32 v120, s54, v120
v_add_u32 v121, 8192, v120
v_add_u32 v122, 16384, v120
v_mfma_f32_16x16x32_bf16 a[4:7], a[192:195], v[100:103], a[4:7]
v_add_u32 v123, 24576, v120
v_lshl_add_u32 v243, v240, 2, v241
v_mfma_f32_16x16x32_bf16 a[8:11], a[192:195], v[104:107], a[8:11]
v_lshrrev_b32 v244, 1, v243
v_and_b32 v244, 3, v244
v_lshlrev_b32 v244, 5, v244
v_mfma_f32_16x16x32_bf16 a[12:15], a[192:195], v[108:111], a[12:15]
v_lshl_add_u32 v244, v243, 7, v244
v_lshl_add_u32 v244, v242, 3, v244
v_mfma_f32_16x16x32_bf16 a[16:19], a[192:195], v[112:115], a[16:19]
v_add_u32 v124, s75, v244
v_xor_b32 v125, 32, v124
v_xor_b32 v126, 64, v124
v_mfma_f32_16x16x32_bf16 a[20:23], a[192:195], v[116:119], a[20:23]
v_xor_b32 v127, 96, v124
s_mul_i32 s54, s68, 12
s_waitcnt lgkmcnt(4)
v_mfma_f32_16x16x32_bf16 a[24:27], a[196:199], v[96:99], a[24:27]
s_lshl_b32 s55, s70, 2
s_add_u32 s54, s54, s55
s_lshl_b32 s54, s54, 17
v_mfma_f32_16x16x32_bf16 a[28:31], a[196:199], v[100:103], a[28:31]
s_lshl_b32 s55, s3, 15
s_add_u32 s54, s54, s55
v_mfma_f32_16x16x32_bf16 a[32:35], a[196:199], v[104:107], a[32:35]
v_lshlrev_b32 v128, 4, v1
v_add_u32 v128, s54, v128
v_add_u32 v129, 131072, v128
v_mfma_f32_16x16x32_bf16 a[36:39], a[196:199], v[108:111], a[36:39]
v_add_u32 v130, 262144, v128
v_add_u32 v131, 393216, v128
v_mfma_f32_16x16x32_bf16 a[40:43], a[196:199], v[112:115], a[40:43]
s_add_u32 m0, s75, 98304
s_nop 0
v_mfma_f32_16x16x32_bf16 a[44:47], a[196:199], v[116:119], a[44:47]
buffer_load_dwordx4 v120, s[40:43], s72 offen offset:0 lds
s_waitcnt lgkmcnt(2)
v_mfma_f32_16x16x32_bf16 a[48:51], a[200:203], v[96:99], a[48:51]
buffer_load_dwordx4 v121, s[40:43], s72 offen offset:1024 lds
v_mfma_f32_16x16x32_bf16 a[52:55], a[200:203], v[100:103], a[52:55]
buffer_load_dwordx4 v122, s[40:43], s72 offen offset:2048 lds
v_mfma_f32_16x16x32_bf16 a[56:59], a[200:203], v[104:107], a[56:59]
buffer_load_dwordx4 v123, s[40:43], s72 offen offset:3072 lds
v_mfma_f32_16x16x32_bf16 a[60:63], a[200:203], v[108:111], a[60:63]
s_add_u32 m0, s75, 114688
s_add_u32 s59, s72, 36864
v_mfma_f32_16x16x32_bf16 a[64:67], a[200:203], v[112:115], a[64:67]
buffer_load_dwordx4 v120, s[40:43], s59 offen offset:0 lds
v_mfma_f32_16x16x32_bf16 a[68:71], a[200:203], v[116:119], a[68:71]
buffer_load_dwordx4 v121, s[40:43], s59 offen offset:1024 lds
s_waitcnt lgkmcnt(0)
v_mfma_f32_16x16x32_bf16 a[72:75], a[204:207], v[96:99], a[72:75]
buffer_load_dwordx4 v122, s[40:43], s59 offen offset:2048 lds
v_mfma_f32_16x16x32_bf16 a[76:79], a[204:207], v[100:103], a[76:79]
buffer_load_dwordx4 v123, s[40:43], s59 offen offset:3072 lds
v_mfma_f32_16x16x32_bf16 a[80:83], a[204:207], v[104:107], a[80:83]
v_mfma_f32_16x16x32_bf16 a[84:87], a[204:207], v[108:111], a[84:87]
v_mfma_f32_16x16x32_bf16 a[88:91], a[204:207], v[112:115], a[88:91]
v_mfma_f32_16x16x32_bf16 a[92:95], a[204:207], v[116:119], a[92:95]
v_mov_b32 v240, v16
v_mov_b32 v241, v17
v_mov_b32 v242, v18
v_mov_b32 v243, v19
v_mov_b32 v244, v20
v_mov_b32 v245, v21
s_nop 1
v_permlane32_swap_b32 v16, v240
v_permlane32_swap_b32 v17, v241
v_permlane32_swap_b32 v18, v242
v_permlane32_swap_b32 v19, v243
v_permlane32_swap_b32 v20, v244
v_permlane32_swap_b32 v21, v245
s_nop 1
v_add_f32 v16, v16, v240
v_add_f32 v17, v17, v241
v_add_f32 v18, v18, v242
v_add_f32 v19, v19, v243
v_add_f32 v20, v20, v244
v_add_f32 v21, v21, v245
v_mov_b32 v240, v16
v_mov_b32 v241, v17
v_mov_b32 v242, v18
v_mov_b32 v243, v19
v_mov_b32 v244, v20
v_mov_b32 v245, v21
s_nop 1
v_permlane16_swap_b32 v16, v240
v_permlane16_swap_b32 v17, v241
v_permlane16_swap_b32 v18, v242
v_permlane16_swap_b32 v19, v243
v_permlane16_swap_b32 v20, v244
v_permlane16_swap_b32 v21, v245
s_nop 1
v_add_f32 v16, v16, v240
v_add_f32 v17, v17, v241
v_add_f32 v18, v18, v242
v_add_f32 v19, v19, v243
v_add_f32 v20, v20, v244
v_add_f32 v21, v21, v245
v_lshlrev_b32 v22, 4, v1
s_mul_i32 s54, s3, 24576
s_xor_b32 s55, s3, 1
s_mul_i32 s56, s55, 24576
v_add_u32 v23, s56, v22
v_add_u32 v22, s54, v22
v_lshlrev_b32 v252, 2, v1
v_add_u32 v252, 147456, v252
s_lshl_b32 s55, s55, 12
v_add_u32 v253, s55, v252
v_add_u32 v252, s75, v252
s_waitcnt vmcnt(11) lgkmcnt(0)
s_barrier
ds_write_b32 v252, v16 offset:0
ds_write_b32 v252, v17 offset:256
ds_write_b32 v252, v18 offset:512
ds_write_b32 v252, v19 offset:768
ds_write_b32 v252, v20 offset:1024
ds_write_b32 v252, v21 offset:1280
ds_write_b128 v22, a[12:15] offset:3072
ds_write_b128 v22, a[36:39] offset:9216
ds_write_b128 v22, a[60:63] offset:15360
ds_write_b128 v22, a[84:87] offset:21504
ds_write_b128 v22, a[16:19] offset:4096
ds_write_b128 v22, a[40:43] offset:10240
ds_write_b128 v22, a[64:67] offset:16384
ds_write_b128 v22, a[88:91] offset:22528
ds_write_b128 v22, a[20:23] offset:5120
ds_write_b128 v22, a[44:47] offset:11264
ds_write_b128 v22, a[68:71] offset:17408
ds_write_b128 v22, a[92:95] offset:23552
ds_write_b128 v22, a[0:3] offset:0
ds_write_b128 v22, a[24:27] offset:6144
ds_write_b128 v22, a[48:51] offset:12288
ds_write_b128 v22, a[72:75] offset:18432
ds_write_b128 v22, a[4:7] offset:1024
ds_write_b128 v22, a[28:31] offset:7168
ds_write_b128 v22, a[52:55] offset:13312
ds_write_b128 v22, a[76:79] offset:19456
ds_write_b128 v22, a[8:11] offset:2048
ds_write_b128 v22, a[32:35] offset:8192
ds_write_b128 v22, a[56:59] offset:14336
ds_write_b128 v22, a[80:83] offset:20480
s_mov_b32 s36, s18
s_mov_b32 s37, s19
s_mov_b32 s38, 12582912
s_mov_b32 s39, 0x20000
s_mul_i32 s54, s49, 12
s_mul_i32 s55, s51, 6
s_add_u32 s54, s54, s55
s_lshl_b32 s54, s54, 5
s_add_u32 s54, s54, s48
s_lshl_b32 s54, s54, 12
s_lshl_b32 s55, s50, 11
s_add_u32 s54, s54, s55
v_lshlrev_b32 v254, 4, v1
s_mul_i32 s55, s50, 393216
s_add_u32 s56, s54, s55
s_sub_u32 s57, s54, s55
s_add_u32 s57, s57, 393216
s_waitcnt lgkmcnt(0)
s_barrier
ds_read_b32 v240, v253 offset:768
ds_read_b32 v242, v253 offset:1024
ds_read_b32 v244, v253 offset:1280
ds_read_b32 v246, v253 offset:0
ds_read_b32 v248, v253 offset:256
ds_read_b32 v250, v253 offset:512
ds_read_b128 v[24:27], v23 offset:3072
ds_read_b128 v[28:31], v23 offset:9216
ds_read_b128 v[32:35], v23 offset:15360
ds_read_b128 v[36:39], v23 offset:21504
ds_read_b128 v[40:43], v23 offset:4096
ds_read_b128 v[44:47], v23 offset:10240
ds_read_b128 v[48:51], v23 offset:16384
ds_read_b128 v[52:55], v23 offset:22528
s_add_u32 m0, s75, 131072
s_add_u32 s59, s72, 73728
buffer_load_dwordx4 v120, s[40:43], s59 offen offset:0 lds
buffer_load_dwordx4 v121, s[40:43], s59 offen offset:1024 lds
buffer_load_dwordx4 v122, s[40:43], s59 offen offset:2048 lds
buffer_load_dwordx4 v123, s[40:43], s59 offen offset:3072 lds
s_waitcnt lgkmcnt(8)
v_add_f32 v16, v16, v240
v_add_f32 v17, v17, v242
v_add_f32 v18, v18, v244
v_add_f32 v19, v19, v246
v_add_f32 v20, v20, v248
v_add_f32 v21, v21, v250
v_rcp_f32 v240, v16
v_rcp_f32 v242, v17
v_rcp_f32 v244, v18
v_rcp_f32 v246, v19
v_rcp_f32 v248, v20
v_rcp_f32 v250, v21
ds_read_b128 v[56:59], v23 offset:5120
ds_read_b128 v[60:63], v23 offset:11264
ds_read_b128 v[64:67], v23 offset:17408
ds_read_b128 v[68:71], v23 offset:23552
s_waitcnt lgkmcnt(8)
v_pk_add_f32 v[144:145], v[144:145], v[24:25]
v_pk_add_f32 v[146:147], v[146:147], v[26:27]
v_pk_add_f32 v[168:169], v[168:169], v[28:29]
v_pk_add_f32 v[170:171], v[170:171], v[30:31]
v_pk_add_f32 v[192:193], v[192:193], v[32:33]
v_pk_add_f32 v[194:195], v[194:195], v[34:35]
v_pk_add_f32 v[216:217], v[216:217], v[36:37]
v_pk_add_f32 v[218:219], v[218:219], v[38:39]
v_pk_mul_f32 v[144:145], v[144:145], v[240:241] op_sel_hi:[1,0]
v_pk_mul_f32 v[146:147], v[146:147], v[240:241] op_sel_hi:[1,0]
v_pk_mul_f32 v[168:169], v[168:169], v[240:241] op_sel_hi:[1,0]
v_pk_mul_f32 v[170:171], v[170:171], v[240:241] op_sel_hi:[1,0]
v_pk_mul_f32 v[192:193], v[192:193], v[240:241] op_sel_hi:[1,0]
v_pk_mul_f32 v[194:195], v[194:195], v[240:241] op_sel_hi:[1,0]
v_pk_mul_f32 v[216:217], v[216:217], v[240:241] op_sel_hi:[1,0]
v_pk_mul_f32 v[218:219], v[218:219], v[240:241] op_sel_hi:[1,0]
v_cvt_pk_bf16_f32 v24, v144, v145
v_cvt_pk_bf16_f32 v25, v146, v147
v_cvt_pk_bf16_f32 v26, v168, v169
v_cvt_pk_bf16_f32 v27, v170, v171
v_cvt_pk_bf16_f32 v28, v192, v193
v_cvt_pk_bf16_f32 v29, v194, v195
v_cvt_pk_bf16_f32 v30, v216, v217
v_cvt_pk_bf16_f32 v31, v218, v219
buffer_store_dwordx4 v[24:27], v254, s[36:39], s56 offen offset:0 sc1
buffer_store_dwordx4 v[28:31], v254, s[36:39], s56 offen offset:1024 sc1
s_add_u32 s56, s56, 131072
ds_read_b128 v[72:75], v23 offset:0
ds_read_b128 v[76:79], v23 offset:6144
ds_read_b128 v[80:83], v23 offset:12288
ds_read_b128 v[84:87], v23 offset:18432
s_waitcnt lgkmcnt(8)
v_pk_add_f32 v[148:149], v[148:149], v[40:41]
v_pk_add_f32 v[150:151], v[150:151], v[42:43]
v_pk_add_f32 v[172:173], v[172:173], v[44:45]
v_pk_add_f32 v[174:175], v[174:175], v[46:47]
v_pk_add_f32 v[196:197], v[196:197], v[48:49]
v_pk_add_f32 v[198:199], v[198:199], v[50:51]
v_pk_add_f32 v[220:221], v[220:221], v[52:53]
v_pk_add_f32 v[222:223], v[222:223], v[54:55]
v_pk_mul_f32 v[148:149], v[148:149], v[242:243] op_sel_hi:[1,0]
v_pk_mul_f32 v[150:151], v[150:151], v[242:243] op_sel_hi:[1,0]
v_pk_mul_f32 v[172:173], v[172:173], v[242:243] op_sel_hi:[1,0]
v_pk_mul_f32 v[174:175], v[174:175], v[242:243] op_sel_hi:[1,0]
v_pk_mul_f32 v[196:197], v[196:197], v[242:243] op_sel_hi:[1,0]
v_pk_mul_f32 v[198:199], v[198:199], v[242:243] op_sel_hi:[1,0]
v_pk_mul_f32 v[220:221], v[220:221], v[242:243] op_sel_hi:[1,0]
v_pk_mul_f32 v[222:223], v[222:223], v[242:243] op_sel_hi:[1,0]
v_cvt_pk_bf16_f32 v40, v148, v149
v_cvt_pk_bf16_f32 v41, v150, v151
v_cvt_pk_bf16_f32 v42, v172, v173
v_cvt_pk_bf16_f32 v43, v174, v175
v_cvt_pk_bf16_f32 v44, v196, v197
v_cvt_pk_bf16_f32 v45, v198, v199
v_cvt_pk_bf16_f32 v46, v220, v221
v_cvt_pk_bf16_f32 v47, v222, v223
buffer_store_dwordx4 v[40:43], v254, s[36:39], s56 offen offset:0 sc1
buffer_store_dwordx4 v[44:47], v254, s[36:39], s56 offen offset:1024 sc1
s_add_u32 s56, s56, 131072
ds_read_b128 v[88:91], v23 offset:1024
ds_read_b128 v[92:95], v23 offset:7168
ds_read_b128 v[96:99], v23 offset:13312
ds_read_b128 v[100:103], v23 offset:19456
s_waitcnt lgkmcnt(8)
v_pk_add_f32 v[152:153], v[152:153], v[56:57]
v_pk_add_f32 v[154:155], v[154:155], v[58:59]
v_pk_add_f32 v[176:177], v[176:177], v[60:61]
v_pk_add_f32 v[178:179], v[178:179], v[62:63]
v_pk_add_f32 v[200:201], v[200:201], v[64:65]
v_pk_add_f32 v[202:203], v[202:203], v[66:67]
v_pk_add_f32 v[224:225], v[224:225], v[68:69]
v_pk_add_f32 v[226:227], v[226:227], v[70:71]
v_pk_mul_f32 v[152:153], v[152:153], v[244:245] op_sel_hi:[1,0]
v_pk_mul_f32 v[154:155], v[154:155], v[244:245] op_sel_hi:[1,0]
v_pk_mul_f32 v[176:177], v[176:177], v[244:245] op_sel_hi:[1,0]
v_pk_mul_f32 v[178:179], v[178:179], v[244:245] op_sel_hi:[1,0]
v_pk_mul_f32 v[200:201], v[200:201], v[244:245] op_sel_hi:[1,0]
v_pk_mul_f32 v[202:203], v[202:203], v[244:245] op_sel_hi:[1,0]
v_pk_mul_f32 v[224:225], v[224:225], v[244:245] op_sel_hi:[1,0]
v_pk_mul_f32 v[226:227], v[226:227], v[244:245] op_sel_hi:[1,0]
v_cvt_pk_bf16_f32 v56, v152, v153
v_cvt_pk_bf16_f32 v57, v154, v155
v_cvt_pk_bf16_f32 v58, v176, v177
v_cvt_pk_bf16_f32 v59, v178, v179
v_cvt_pk_bf16_f32 v60, v200, v201
v_cvt_pk_bf16_f32 v61, v202, v203
v_cvt_pk_bf16_f32 v62, v224, v225
v_cvt_pk_bf16_f32 v63, v226, v227
buffer_store_dwordx4 v[56:59], v254, s[36:39], s56 offen offset:0 sc1
buffer_store_dwordx4 v[60:63], v254, s[36:39], s56 offen offset:1024 sc1
ds_read_b128 v[104:107], v23 offset:2048
ds_read_b128 v[108:111], v23 offset:8192
ds_read_b128 v[112:115], v23 offset:14336
ds_read_b128 v[116:119], v23 offset:20480
s_waitcnt lgkmcnt(8)
v_pk_add_f32 v[156:157], v[156:157], v[72:73]
v_pk_add_f32 v[158:159], v[158:159], v[74:75]
v_pk_add_f32 v[180:181], v[180:181], v[76:77]
v_pk_add_f32 v[182:183], v[182:183], v[78:79]
v_pk_add_f32 v[204:205], v[204:205], v[80:81]
v_pk_add_f32 v[206:207], v[206:207], v[82:83]
v_pk_add_f32 v[228:229], v[228:229], v[84:85]
v_pk_add_f32 v[230:231], v[230:231], v[86:87]
v_pk_mul_f32 v[156:157], v[156:157], v[246:247] op_sel_hi:[1,0]
v_pk_mul_f32 v[158:159], v[158:159], v[246:247] op_sel_hi:[1,0]
v_pk_mul_f32 v[180:181], v[180:181], v[246:247] op_sel_hi:[1,0]
v_pk_mul_f32 v[182:183], v[182:183], v[246:247] op_sel_hi:[1,0]
v_pk_mul_f32 v[204:205], v[204:205], v[246:247] op_sel_hi:[1,0]
v_pk_mul_f32 v[206:207], v[206:207], v[246:247] op_sel_hi:[1,0]
v_pk_mul_f32 v[228:229], v[228:229], v[246:247] op_sel_hi:[1,0]
v_pk_mul_f32 v[230:231], v[230:231], v[246:247] op_sel_hi:[1,0]
v_cvt_pk_bf16_f32 v72, v156, v157
v_cvt_pk_bf16_f32 v73, v158, v159
v_cvt_pk_bf16_f32 v74, v180, v181
v_cvt_pk_bf16_f32 v75, v182, v183
v_cvt_pk_bf16_f32 v76, v204, v205
v_cvt_pk_bf16_f32 v77, v206, v207
v_cvt_pk_bf16_f32 v78, v228, v229
v_cvt_pk_bf16_f32 v79, v230, v231
buffer_store_dwordx4 v[72:75], v254, s[36:39], s57 offen offset:0 sc1
buffer_store_dwordx4 v[76:79], v254, s[36:39], s57 offen offset:1024 sc1
s_add_u32 s57, s57, 131072
s_waitcnt lgkmcnt(4)
v_pk_add_f32 v[160:161], v[160:161], v[88:89]
v_pk_add_f32 v[162:163], v[162:163], v[90:91]
v_pk_add_f32 v[184:185], v[184:185], v[92:93]
v_pk_add_f32 v[186:187], v[186:187], v[94:95]
v_pk_add_f32 v[208:209], v[208:209], v[96:97]
v_pk_add_f32 v[210:211], v[210:211], v[98:99]
v_pk_add_f32 v[232:233], v[232:233], v[100:101]
v_pk_add_f32 v[234:235], v[234:235], v[102:103]
v_pk_mul_f32 v[160:161], v[160:161], v[248:249] op_sel_hi:[1,0]
v_pk_mul_f32 v[162:163], v[162:163], v[248:249] op_sel_hi:[1,0]
v_pk_mul_f32 v[184:185], v[184:185], v[248:249] op_sel_hi:[1,0]
v_pk_mul_f32 v[186:187], v[186:187], v[248:249] op_sel_hi:[1,0]
v_pk_mul_f32 v[208:209], v[208:209], v[248:249] op_sel_hi:[1,0]
v_pk_mul_f32 v[210:211], v[210:211], v[248:249] op_sel_hi:[1,0]
v_pk_mul_f32 v[232:233], v[232:233], v[248:249] op_sel_hi:[1,0]
v_pk_mul_f32 v[234:235], v[234:235], v[248:249] op_sel_hi:[1,0]
v_cvt_pk_bf16_f32 v88, v160, v161
v_cvt_pk_bf16_f32 v89, v162, v163
v_cvt_pk_bf16_f32 v90, v184, v185
v_cvt_pk_bf16_f32 v91, v186, v187
v_cvt_pk_bf16_f32 v92, v208, v209
v_cvt_pk_bf16_f32 v93, v210, v211
v_cvt_pk_bf16_f32 v94, v232, v233
v_cvt_pk_bf16_f32 v95, v234, v235
buffer_store_dwordx4 v[88:91], v254, s[36:39], s57 offen offset:0 sc1
buffer_store_dwordx4 v[92:95], v254, s[36:39], s57 offen offset:1024 sc1
s_add_u32 s57, s57, 131072
s_waitcnt lgkmcnt(0)
v_pk_add_f32 v[164:165], v[164:165], v[104:105]
v_pk_add_f32 v[166:167], v[166:167], v[106:107]
v_pk_add_f32 v[188:189], v[188:189], v[108:109]
v_pk_add_f32 v[190:191], v[190:191], v[110:111]
v_pk_add_f32 v[212:213], v[212:213], v[112:113]
v_pk_add_f32 v[214:215], v[214:215], v[114:115]
v_pk_add_f32 v[236:237], v[236:237], v[116:117]
v_pk_add_f32 v[238:239], v[238:239], v[118:119]
v_pk_mul_f32 v[164:165], v[164:165], v[250:251] op_sel_hi:[1,0]
v_pk_mul_f32 v[166:167], v[166:167], v[250:251] op_sel_hi:[1,0]
v_pk_mul_f32 v[188:189], v[188:189], v[250:251] op_sel_hi:[1,0]
v_pk_mul_f32 v[190:191], v[190:191], v[250:251] op_sel_hi:[1,0]
v_pk_mul_f32 v[212:213], v[212:213], v[250:251] op_sel_hi:[1,0]
v_pk_mul_f32 v[214:215], v[214:215], v[250:251] op_sel_hi:[1,0]
v_pk_mul_f32 v[236:237], v[236:237], v[250:251] op_sel_hi:[1,0]
v_pk_mul_f32 v[238:239], v[238:239], v[250:251] op_sel_hi:[1,0]
v_cvt_pk_bf16_f32 v104, v164, v165
v_cvt_pk_bf16_f32 v105, v166, v167
v_cvt_pk_bf16_f32 v106, v188, v189
v_cvt_pk_bf16_f32 v107, v190, v191
v_cvt_pk_bf16_f32 v108, v212, v213
v_cvt_pk_bf16_f32 v109, v214, v215
v_cvt_pk_bf16_f32 v110, v236, v237
v_cvt_pk_bf16_f32 v111, v238, v239
buffer_store_dwordx4 v[104:107], v254, s[36:39], s57 offen offset:0 sc1
buffer_store_dwordx4 v[108:111], v254, s[36:39], s57 offen offset:1024 sc1
v_min3_f32 v240, v16, v17, v18
v_max3_f32 v241, v16, v17, v18
v_min3_f32 v240, v240, v19, v20
v_max3_f32 v241, v241, v19, v20
v_min_f32 v240, v240, v21
v_max_f32 v241, v241, v21
v_mov_b32 v242, 0
v_mov_b32 v243, 0
v_mov_b32 v244, 0
v_mov_b32 v245, 0
v_mov_b32 v246, 0
v_dot2_f32_bf16 v242, v24, v246, v242
v_dot2_f32_bf16 v243, v25, v246, v243
v_dot2_f32_bf16 v244, v26, v246, v244
v_dot2_f32_bf16 v245, v27, v246, v245
v_dot2_f32_bf16 v242, v28, v246, v242
v_dot2_f32_bf16 v243, v29, v246, v243
v_dot2_f32_bf16 v244, v30, v246, v244
v_dot2_f32_bf16 v245, v31, v246, v245
v_dot2_f32_bf16 v242, v40, v246, v242
v_dot2_f32_bf16 v243, v41, v246, v243
v_dot2_f32_bf16 v244, v42, v246, v244
v_dot2_f32_bf16 v245, v43, v246, v245
v_dot2_f32_bf16 v242, v44, v246, v242
v_dot2_f32_bf16 v243, v45, v246, v243
v_dot2_f32_bf16 v244, v46, v246, v244
v_dot2_f32_bf16 v245, v47, v246, v245
v_dot2_f32_bf16 v242, v56, v246, v242
v_dot2_f32_bf16 v243, v57, v246, v243
v_dot2_f32_bf16 v244, v58, v246, v244
v_dot2_f32_bf16 v245, v59, v246, v245
v_dot2_f32_bf16 v242, v60, v246, v242
v_dot2_f32_bf16 v243, v61, v246, v243
v_dot2_f32_bf16 v244, v62, v246, v244
v_dot2_f32_bf16 v245, v63, v246, v245
v_dot2_f32_bf16 v242, v72, v246, v242
v_dot2_f32_bf16 v243, v73, v246, v243
v_dot2_f32_bf16 v244, v74, v246, v244
v_dot2_f32_bf16 v245, v75, v246, v245
v_dot2_f32_bf16 v242, v76, v246, v242
v_dot2_f32_bf16 v243, v77, v246, v243
v_dot2_f32_bf16 v244, v78, v246, v244
v_dot2_f32_bf16 v245, v79, v246, v245
v_dot2_f32_bf16 v242, v88, v246, v242
v_dot2_f32_bf16 v243, v89, v246, v243
v_dot2_f32_bf16 v244, v90, v246, v244
v_dot2_f32_bf16 v245, v91, v246, v245
v_dot2_f32_bf16 v242, v92, v246, v242
v_dot2_f32_bf16 v243, v93, v246, v243
v_dot2_f32_bf16 v244, v94, v246, v244
v_dot2_f32_bf16 v245, v95, v246, v245
v_dot2_f32_bf16 v242, v104, v246, v242
v_dot2_f32_bf16 v243, v105, v246, v243
v_dot2_f32_bf16 v244, v106, v246, v244
v_dot2_f32_bf16 v245, v107, v246, v245
v_dot2_f32_bf16 v242, v108, v246, v242
v_dot2_f32_bf16 v243, v109, v246, v243
v_dot2_f32_bf16 v244, v110, v246, v244
v_dot2_f32_bf16 v245, v111, v246, v245
s_mov_b32 s54, 0x17800000
s_mov_b32 s55, 0x67800000
v_cmp_gt_f32 s[56:57], s54, v240
v_cmp_lt_f32 vcc, s55, v241
v_add_f32 v242, v242, v243
v_add_f32 v244, v244, v245
v_add_f32 v242, v242, v244
s_nop 0
s_or_b64 s[56:57], s[56:57], vcc
v_cmp_u_f32 vcc, v242, v242
v_and_b32 v247, 3, v1
v_lshlrev_b32 v247, 12, v247
s_lshl_b32 s55, s3, 2
s_add_u32 s55, s55, 149504
v_add_u32 v247, s55, v247
s_or_b64 s[56:57], s[56:57], vcc
s_cmp_lg_u64 s[56:57], 0
s_cselect_b32 s54, 1, 0
v_mov_b32 v248, s54
ds_write_b32 v247, v248
s_add_u32 s55, s75, 149504
v_mov_b32 v249, s55
s_waitcnt vmcnt(0) lgkmcnt(0)
s_barrier
ds_read_b128 v[252:255], v249
s_waitcnt lgkmcnt(0)
v_or_b32 v252, v252, v253
v_or_b32 v254, v254, v255
v_or_b32 v252, v252, v254
s_nop 0
v_readfirstlane_b32 s54, v252
s_nop 3
s_andn2_b32 s54, s54, s65
s_cmp_lg_u32 s54, 0
s_cbranch_scc1 L_fallback
s_mov_b32 s28, s16
s_mov_b32 s29, s17
s_mov_b32 s30, 256
s_mov_b32 s31, 0x20000
s_cmp_lg_u32 s3, 0
s_cbranch_scc1 L_nosig
s_lshl_b32 s58, s49, 5
v_mov_b32 v243, 1
v_mov_b32 v244, s58
s_mov_b64 s[76:77], exec
s_mov_b64 exec, 1
buffer_atomic_add v243, v244, s[28:31], 0 offen sc1
s_mov_b64 exec, s[76:77]
L_nosig:
s_cmp_ge_u32 s69, 27
s_cbranch_scc1 L_signal_only
s_lshl_b32 s58, s68, 5
v_mov_b32 v247, s58
s_add_u32 m0, s75, 0
s_add_u32 s59, s72, 110592
buffer_load_dwordx4 v120, s[40:43], s59 offen offset:0 lds
buffer_load_dwordx4 v121, s[40:43], s59 offen offset:1024 lds
buffer_load_dwordx4 v122, s[40:43], s59 offen offset:2048 lds
buffer_load_dwordx4 v123, s[40:43], s59 offen offset:3072 lds
s_add_u32 m0, s75, 16384
s_add_u32 s72, s72, 147456
s_cmp_eq_u32 s72, 1179648
s_cselect_b32 s72, 0, s72
buffer_load_dwordx4 v120, s[40:43], s72 offen offset:0 lds
buffer_load_dwordx4 v121, s[40:43], s72 offen offset:1024 lds
buffer_load_dwordx4 v122, s[40:43], s72 offen offset:2048 lds
buffer_load_dwordx4 v123, s[40:43], s72 offen offset:3072 lds
v_add_u32 v124, 0x10000, v124
v_add_u32 v125, 0x10000, v125
v_add_u32 v126, 0x10000, v126
v_add_u32 v127, 0x10000, v127
ds_read_b64_tr_b16 a[192:193], v124 offset:32768
ds_read_b64_tr_b16 a[194:195], v124 offset:34816
ds_read_b64_tr_b16 a[196:197], v125 offset:32768
ds_read_b64_tr_b16 a[198:199], v125 offset:34816
ds_read_b64_tr_b16 a[200:201], v126 offset:32768
ds_read_b64_tr_b16 a[202:203], v126 offset:34816
ds_read_b64_tr_b16 a[204:205], v127 offset:32768
ds_read_b64_tr_b16 a[206:207], v127 offset:34816
s_add_u32 m0, s75, 32768
s_add_u32 s59, s72, 36864
buffer_load_dwordx4 v120, s[40:43], s59 offen offset:0 lds
buffer_load_dwordx4 v121, s[40:43], s59 offen offset:1024 lds
buffer_load_dwordx4 v122, s[40:43], s59 offen offset:2048 lds
buffer_load_dwordx4 v123, s[40:43], s59 offen offset:3072 lds
s_add_u32 m0, s75, 49152
s_add_u32 s59, s72, 73728
buffer_load_dwordx4 v120, s[40:43], s59 offen offset:0 lds
buffer_load_dwordx4 v121, s[40:43], s59 offen offset:1024 lds
buffer_load_dwordx4 v122, s[40:43], s59 offen offset:2048 lds
buffer_load_dwordx4 v123, s[40:43], s59 offen offset:3072 lds
ds_read_b64_tr_b16 a[208:209], v124 offset:49152
ds_read_b64_tr_b16 a[210:211], v124 offset:51200
ds_read_b64_tr_b16 a[212:213], v125 offset:49152
ds_read_b64_tr_b16 a[214:215], v125 offset:51200
ds_read_b64_tr_b16 a[216:217], v126 offset:49152
ds_read_b64_tr_b16 a[218:219], v126 offset:51200
ds_read_b64_tr_b16 a[220:221], v127 offset:49152
ds_read_b64_tr_b16 a[222:223], v127 offset:51200
s_add_u32 m0, s75, 65536
s_add_u32 s59, s72, 110592
buffer_load_dwordx4 v120, s[40:43], s59 offen offset:0 lds
buffer_load_dwordx4 v121, s[40:43], s59 offen offset:1024 lds
buffer_load_dwordx4 v122, s[40:43], s59 offen offset:2048 lds
buffer_load_dwordx4 v123, s[40:43], s59 offen offset:3072 lds
s_add_u32 m0, s75, 81920
s_add_u32 s72, s72, 147456
s_cmp_eq_u32 s72, 1179648
s_cselect_b32 s72, 0, s72
buffer_load_dwordx4 v120, s[40:43], s72 offen offset:0 lds
buffer_load_dwordx4 v121, s[40:43], s72 offen offset:1024 lds
buffer_load_dwordx4 v122, s[40:43], s72 offen offset:2048 lds
buffer_load_dwordx4 v123, s[40:43], s72 offen offset:3072 lds
v_add_u32 v124, 0x10000, v124
v_add_u32 v125, 0x10000, v125
v_add_u32 v126, 0x10000, v126
v_add_u32 v127, 0x10000, v127
ds_read_b64_tr_b16 a[224:225], v124 offset:0
ds_read_b64_tr_b16 a[226:227], v124 offset:2048
ds_read_b64_tr_b16 a[228:229], v125 offset:0
ds_read_b64_tr_b16 a[230:231], v125 offset:2048
ds_read_b64_tr_b16 a[232:233], v126 offset:0
ds_read_b64_tr_b16 a[234:235], v126 offset:2048
ds_read_b64_tr_b16 a[236:237], v127 offset:0
ds_read_b64_tr_b16 a[238:239], v127 offset:2048
s_add_u32 m0, s75, 147456
s_add_u32 s59, s72, 36864
buffer_load_dwordx4 v120, s[40:43], s59 offen offset:0 lds
buffer_load_dwordx4 v121, s[40:43], s59 offen offset:1024 lds
buffer_load_dwordx4 v122, s[40:43], s59 offen offset:2048 lds
buffer_load_dwordx4 v123, s[40:43], s59 offen offset:3072 lds
s_waitcnt lgkmcnt(15)
s_add_u32 m0, s75, 98304
s_add_u32 s59, s72, 73728
buffer_load_dwordx4 v120, s[40:43], s59 offen offset:0 lds
buffer_load_dwordx4 v121, s[40:43], s59 offen offset:1024 lds
buffer_load_dwordx4 v122, s[40:43], s59 offen offset:2048 lds
buffer_load_dwordx4 v123, s[40:43], s59 offen offset:3072 lds
s_waitcnt vmcnt(28)
v_add_u32 v124, 0xfffe0000, v124
v_add_u32 v125, 0xfffe0000, v125
v_add_u32 v126, 0xfffe0000, v126
v_add_u32 v127, 0xfffe0000, v127
ds_read_b64_tr_b16 a[240:241], v124 offset:0
ds_read_b64_tr_b16 a[242:243], v124 offset:2048
ds_read_b64_tr_b16 a[244:245], v125 offset:0
ds_read_b64_tr_b16 a[246:247], v125 offset:2048
ds_read_b64_tr_b16 a[248:249], v126 offset:0
ds_read_b64_tr_b16 a[250:251], v126 offset:2048
ds_read_b64_tr_b16 a[252:253], v127 offset:0
ds_read_b64_tr_b16 a[254:255], v127 offset:2048
s_waitcnt lgkmcnt(15)
s_add_u32 m0, s75, 114688
s_add_u32 s59, s72, 110592
buffer_load_dwordx4 v120, s[40:43], s59 offen offset:0 lds
buffer_load_dwordx4 v121, s[40:43], s59 offen offset:1024 lds
buffer_load_dwordx4 v122, s[40:43], s59 offen offset:2048 lds
buffer_load_dwordx4 v123, s[40:43], s59 offen offset:3072 lds
s_waitcnt lgkmcnt(8)
s_add_u32 m0, s75, 131072
s_add_u32 s72, s72, 147456
s_cmp_eq_u32 s72, 1179648
s_cselect_b32 s72, 0, s72
buffer_load_dwordx4 v120, s[40:43], s72 offen offset:0 lds
buffer_load_dwordx4 v121, s[40:43], s72 offen offset:1024 lds
buffer_load_dwordx4 v122, s[40:43], s72 offen offset:2048 lds
buffer_load_dwordx4 v123, s[40:43], s72 offen offset:3072 lds
s_waitcnt vmcnt(32)
ds_read_b64_tr_b16 a[0:1], v124 offset:16384
ds_read_b64_tr_b16 a[2:3], v124 offset:18432
ds_read_b64_tr_b16 a[4:5], v125 offset:16384
ds_read_b64_tr_b16 a[6:7], v125 offset:18432
ds_read_b64_tr_b16 a[8:9], v126 offset:16384
ds_read_b64_tr_b16 a[10:11], v126 offset:18432
ds_read_b64_tr_b16 a[12:13], v127 offset:16384
ds_read_b64_tr_b16 a[14:15], v127 offset:18432
s_waitcnt lgkmcnt(8)
s_add_u32 m0, s75, 0
s_add_u32 s59, s72, 36864
buffer_load_dwordx4 v120, s[40:43], s59 offen offset:0 lds
buffer_load_dwordx4 v121, s[40:43], s59 offen offset:1024 lds
buffer_load_dwordx4 v122, s[40:43], s59 offen offset:2048 lds
buffer_load_dwordx4 v123, s[40:43], s59 offen offset:3072 lds
s_waitcnt vmcnt(32)
ds_read_b64_tr_b16 a[16:17], v124 offset:32768
ds_read_b64_tr_b16 a[18:19], v124 offset:34816
ds_read_b64_tr_b16 a[20:21], v125 offset:32768
ds_read_b64_tr_b16 a[22:23], v125 offset:34816
ds_read_b64_tr_b16 a[24:25], v126 offset:32768
ds_read_b64_tr_b16 a[26:27], v126 offset:34816
ds_read_b64_tr_b16 a[28:29], v127 offset:32768
ds_read_b64_tr_b16 a[30:31], v127 offset:34816
s_waitcnt lgkmcnt(8)
s_add_u32 m0, s75, 16384
s_add_u32 s59, s72, 73728
buffer_load_dwordx4 v120, s[40:43], s59 offen offset:0 lds
buffer_load_dwordx4 v121, s[40:43], s59 offen offset:1024 lds
buffer_load_dwordx4 v122, s[40:43], s59 offen offset:2048 lds
buffer_load_dwordx4 v123, s[40:43], s59 offen offset:3072 lds
s_waitcnt vmcnt(32)
ds_read_b64_tr_b16 a[32:33], v124 offset:49152
ds_read_b64_tr_b16 a[34:35], v124 offset:51200
ds_read_b64_tr_b16 a[36:37], v125 offset:49152
ds_read_b64_tr_b16 a[38:39], v125 offset:51200
ds_read_b64_tr_b16 a[40:41], v126 offset:49152
ds_read_b64_tr_b16 a[42:43], v126 offset:51200
ds_read_b64_tr_b16 a[44:45], v127 offset:49152
ds_read_b64_tr_b16 a[46:47], v127 offset:51200
s_waitcnt lgkmcnt(8)
s_add_u32 m0, s75, 32768
s_add_u32 s59, s72, 110592
buffer_load_dwordx4 v120, s[40:43], s59 offen offset:0 lds
buffer_load_dwordx4 v121, s[40:43], s59 offen offset:1024 lds
buffer_load_dwordx4 v122, s[40:43], s59 offen offset:2048 lds
buffer_load_dwordx4 v123, s[40:43], s59 offen offset:3072 lds
s_waitcnt vmcnt(32)
v_add_u32 v124, 0x10000, v124
v_add_u32 v125, 0x10000, v125
v_add_u32 v126, 0x10000, v126
v_add_u32 v127, 0x10000, v127
ds_read_b64_tr_b16 a[48:49], v124 offset:0
ds_read_b64_tr_b16 a[50:51], v124 offset:2048
ds_read_b64_tr_b16 a[52:53], v125 offset:0
ds_read_b64_tr_b16 a[54:55], v125 offset:2048
ds_read_b64_tr_b16 a[56:57], v126 offset:0
ds_read_b64_tr_b16 a[58:59], v126 offset:2048
ds_read_b64_tr_b16 a[60:61], v127 offset:0
ds_read_b64_tr_b16 a[62:63], v127 offset:2048
s_waitcnt lgkmcnt(8)
s_add_u32 m0, s75, 49152
s_add_u32 s72, s72, 147456
s_cmp_eq_u32 s72, 1179648
s_cselect_b32 s72, 0, s72
buffer_load_dwordx4 v120, s[40:43], s72 offen offset:0 lds
buffer_load_dwordx4 v121, s[40:43], s72 offen offset:1024 lds
buffer_load_dwordx4 v122, s[40:43], s72 offen offset:2048 lds
buffer_load_dwordx4 v123, s[40:43], s72 offen offset:3072 lds
s_waitcnt vmcnt(32)
ds_read_b64_tr_b16 a[64:65], v124 offset:16384
ds_read_b64_tr_b16 a[66:67], v124 offset:18432
ds_read_b64_tr_b16 a[68:69], v125 offset:16384
ds_read_b64_tr_b16 a[70:71], v125 offset:18432
ds_read_b64_tr_b16 a[72:73], v126 offset:16384
ds_read_b64_tr_b16 a[74:75], v126 offset:18432
ds_read_b64_tr_b16 a[76:77], v127 offset:16384
ds_read_b64_tr_b16 a[78:79], v127 offset:18432
s_waitcnt lgkmcnt(8)
s_add_u32 m0, s75, 65536
s_add_u32 s59, s72, 36864
buffer_load_dwordx4 v120, s[40:43], s59 offen offset:0 lds
buffer_load_dwordx4 v121, s[40:43], s59 offen offset:1024 lds
buffer_load_dwordx4 v122, s[40:43], s59 offen offset:2048 lds
buffer_load_dwordx4 v123, s[40:43], s59 offen offset:3072 lds
s_waitcnt vmcnt(32)
v_add_u32 v124, 0x10000, v124
v_add_u32 v125, 0x10000, v125
v_add_u32 v126, 0x10000, v126
v_add_u32 v127, 0x10000, v127
ds_read_b64_tr_b16 a[80:81], v124 offset:16384
ds_read_b64_tr_b16 a[82:83], v124 offset:18432
ds_read_b64_tr_b16 a[84:85], v125 offset:16384
ds_read_b64_tr_b16 a[86:87], v125 offset:18432
ds_read_b64_tr_b16 a[88:89], v126 offset:16384
ds_read_b64_tr_b16 a[90:91], v126 offset:18432
ds_read_b64_tr_b16 a[92:93], v127 offset:16384
ds_read_b64_tr_b16 a[94:95], v127 offset:18432
s_waitcnt lgkmcnt(8)
s_add_u32 m0, s75, 81920
s_add_u32 s59, s72, 73728
buffer_load_dwordx4 v120, s[40:43], s59 offen offset:0 lds
buffer_load_dwordx4 v121, s[40:43], s59 offen offset:1024 lds
buffer_load_dwordx4 v122, s[40:43], s59 offen offset:2048 lds
buffer_load_dwordx4 v123, s[40:43], s59 offen offset:3072 lds
s_waitcnt vmcnt(32)
v_add_u32 v124, 0xffff0000, v124
v_add_u32 v125, 0xffff0000, v125
v_add_u32 v126, 0xffff0000, v126
v_add_u32 v127, 0xffff0000, v127
ds_read_b64_tr_b16 a[96:97], v124 offset:32768
ds_read_b64_tr_b16 a[98:99], v124 offset:34816
ds_read_b64_tr_b16 a[100:101], v125 offset:32768
ds_read_b64_tr_b16 a[102:103], v125 offset:34816
ds_read_b64_tr_b16 a[104:105], v126 offset:32768
ds_read_b64_tr_b16 a[106:107], v126 offset:34816
ds_read_b64_tr_b16 a[108:109], v127 offset:32768
ds_read_b64_tr_b16 a[110:111], v127 offset:34816
s_waitcnt lgkmcnt(8)
s_add_u32 m0, s75, 147456
s_add_u32 s59, s72, 110592
buffer_load_dwordx4 v120, s[40:43], s59 offen offset:0 lds
buffer_load_dwordx4 v121, s[40:43], s59 offen offset:1024 lds
buffer_load_dwordx4 v122, s[40:43], s59 offen offset:2048 lds
buffer_load_dwordx4 v123, s[40:43], s59 offen offset:3072 lds
s_waitcnt vmcnt(32)
ds_read_b64_tr_b16 a[112:113], v124 offset:49152
ds_read_b64_tr_b16 a[114:115], v124 offset:51200
ds_read_b64_tr_b16 a[116:117], v125 offset:49152
ds_read_b64_tr_b16 a[118:119], v125 offset:51200
ds_read_b64_tr_b16 a[120:121], v126 offset:49152
ds_read_b64_tr_b16 a[122:123], v126 offset:51200
ds_read_b64_tr_b16 a[124:125], v127 offset:49152
ds_read_b64_tr_b16 a[126:127], v127 offset:51200
s_waitcnt lgkmcnt(8)
s_add_u32 m0, s75, 98304
s_add_u32 s72, s72, 147456
s_cmp_eq_u32 s72, 1179648
s_cselect_b32 s72, 0, s72
buffer_load_dwordx4 v120, s[40:43], s72 offen offset:0 lds
buffer_load_dwordx4 v121, s[40:43], s72 offen offset:1024 lds
buffer_load_dwordx4 v122, s[40:43], s72 offen offset:2048 lds
buffer_load_dwordx4 v123, s[40:43], s72 offen offset:3072 lds
s_waitcnt vmcnt(32)
v_add_u32 v124, 0x10000, v124
v_add_u32 v125, 0x10000, v125
v_add_u32 v126, 0x10000, v126
v_add_u32 v127, 0x10000, v127
ds_read_b64_tr_b16 a[128:129], v124 offset:0
ds_read_b64_tr_b16 a[130:131], v124 offset:2048
ds_read_b64_tr_b16 a[132:133], v125 offset:0
ds_read_b64_tr_b16 a[134:135], v125 offset:2048
ds_read_b64_tr_b16 a[136:137], v126 offset:0
ds_read_b64_tr_b16 a[138:139], v126 offset:2048
ds_read_b64_tr_b16 a[140:141], v127 offset:0
ds_read_b64_tr_b16 a[142:143], v127 offset:2048
s_waitcnt lgkmcnt(8)
s_add_u32 m0, s75, 114688
s_add_u32 s59, s72, 36864
buffer_load_dwordx4 v120, s[40:43], s59 offen offset:0 lds
buffer_load_dwordx4 v121, s[40:43], s59 offen offset:1024 lds
buffer_load_dwordx4 v122, s[40:43], s59 offen offset:2048 lds
buffer_load_dwordx4 v123, s[40:43], s59 offen offset:3072 lds
s_waitcnt vmcnt(32)
v_add_u32 v124, 0xfffe0000, v124
v_add_u32 v125, 0xfffe0000, v125
v_add_u32 v126, 0xfffe0000, v126
v_add_u32 v127, 0xfffe0000, v127
ds_read_b64_tr_b16 a[144:145], v124 offset:0
ds_read_b64_tr_b16 a[146:147], v124 offset:2048
ds_read_b64_tr_b16 a[148:149], v125 offset:0
ds_read_b64_tr_b16 a[150:151], v125 offset:2048
ds_read_b64_tr_b16 a[152:153], v126 offset:0
ds_read_b64_tr_b16 a[154:155], v126 offset:2048
ds_read_b64_tr_b16 a[156:157], v127 offset:0
ds_read_b64_tr_b16 a[158:159], v127 offset:2048
s_waitcnt lgkmcnt(8)
s_add_u32 m0, s75, 131072
s_add_u32 s59, s72, 73728
buffer_load_dwordx4 v120, s[40:43], s59 offen offset:0 lds
buffer_load_dwordx4 v121, s[40:43], s59 offen offset:1024 lds
buffer_load_dwordx4 v122, s[40:43], s59 offen offset:2048 lds
buffer_load_dwordx4 v123, s[40:43], s59 offen offset:3072 lds
s_waitcnt vmcnt(32)
ds_read_b64_tr_b16 a[160:161], v124 offset:16384
ds_read_b64_tr_b16 a[162:163], v124 offset:18432
ds_read_b64_tr_b16 a[164:165], v125 offset:16384
ds_read_b64_tr_b16 a[166:167], v125 offset:18432
ds_read_b64_tr_b16 a[168:169], v126 offset:16384
ds_read_b64_tr_b16 a[170:171], v126 offset:18432
ds_read_b64_tr_b16 a[172:173], v127 offset:16384
ds_read_b64_tr_b16 a[174:175], v127 offset:18432
s_waitcnt lgkmcnt(8)
s_add_u32 m0, s75, 0
s_add_u32 s59, s72, 110592
buffer_load_dwordx4 v120, s[40:43], s59 offen offset:0 lds
buffer_load_dwordx4 v121, s[40:43], s59 offen offset:1024 lds
buffer_load_dwordx4 v122, s[40:43], s59 offen offset:2048 lds
buffer_load_dwordx4 v123, s[40:43], s59 offen offset:3072 lds
s_waitcnt vmcnt(32)
ds_read_b64_tr_b16 a[176:177], v124 offset:32768
ds_read_b64_tr_b16 a[178:179], v124 offset:34816
ds_read_b64_tr_b16 a[180:181], v125 offset:32768
ds_read_b64_tr_b16 a[182:183], v125 offset:34816
ds_read_b64_tr_b16 a[184:185], v126 offset:32768
ds_read_b64_tr_b16 a[186:187], v126 offset:34816
ds_read_b64_tr_b16 a[188:189], v127 offset:32768
ds_read_b64_tr_b16 a[190:191], v127 offset:34816
s_waitcnt lgkmcnt(8)
s_add_u32 m0, s75, 16384
s_add_u32 s72, s72, 147456
s_cmp_eq_u32 s72, 1179648
s_cselect_b32 s72, 0, s72
buffer_load_dwordx4 v120, s[40:43], s72 offen offset:0 lds
buffer_load_dwordx4 v121, s[40:43], s72 offen offset:1024 lds
buffer_load_dwordx4 v122, s[40:43], s72 offen offset:2048 lds
buffer_load_dwordx4 v123, s[40:43], s72 offen offset:3072 lds
s_waitcnt vmcnt(32)
ds_read_b64_tr_b16 v[8:9], v124 offset:49152
ds_read_b64_tr_b16 v[10:11], v124 offset:51200
ds_read_b64_tr_b16 v[12:13], v125 offset:49152
ds_read_b64_tr_b16 v[14:15], v125 offset:51200
ds_read_b64_tr_b16 v[16:17], v126 offset:49152
ds_read_b64_tr_b16 v[18:19], v126 offset:51200
ds_read_b64_tr_b16 v[20:21], v127 offset:49152
ds_read_b64_tr_b16 v[22:23], v127 offset:51200
s_waitcnt lgkmcnt(8)
s_add_u32 m0, s75, 32768
s_add_u32 s59, s72, 36864
buffer_load_dwordx4 v120, s[40:43], s59 offen offset:0 lds
buffer_load_dwordx4 v121, s[40:43], s59 offen offset:1024 lds
buffer_load_dwordx4 v122, s[40:43], s59 offen offset:2048 lds
buffer_load_dwordx4 v123, s[40:43], s59 offen offset:3072 lds
buffer_load_dword v246, v247, s[28:31], 0 offen sc1
s_waitcnt vmcnt(33)
v_add_u32 v124, 0x10000, v124
v_add_u32 v125, 0x10000, v125
v_add_u32 v126, 0x10000, v126
v_add_u32 v127, 0x10000, v127
ds_read_b64_tr_b16 v[72:73], v124 offset:0
ds_read_b64_tr_b16 v[74:75], v124 offset:2048
ds_read_b64_tr_b16 v[76:77], v125 offset:0
ds_read_b64_tr_b16 v[78:79], v125 offset:2048
ds_read_b64_tr_b16 v[80:81], v126 offset:0
ds_read_b64_tr_b16 v[82:83], v126 offset:2048
ds_read_b64_tr_b16 v[84:85], v127 offset:0
ds_read_b64_tr_b16 v[86:87], v127 offset:2048
s_waitcnt lgkmcnt(8)
s_add_u32 m0, s75, 49152
s_add_u32 s59, s72, 73728
buffer_load_dwordx4 v120, s[40:43], s59 offen offset:0 lds
buffer_load_dwordx4 v121, s[40:43], s59 offen offset:1024 lds
buffer_load_dwordx4 v122, s[40:43], s59 offen offset:2048 lds
buffer_load_dwordx4 v123, s[40:43], s59 offen offset:3072 lds
s_waitcnt vmcnt(33)
ds_read_b64_tr_b16 v[88:89], v124 offset:16384
ds_read_b64_tr_b16 v[90:91], v124 offset:18432
ds_read_b64_tr_b16 v[92:93], v125 offset:16384
ds_read_b64_tr_b16 v[94:95], v125 offset:18432
ds_read_b64_tr_b16 v[96:97], v126 offset:16384
ds_read_b64_tr_b16 v[98:99], v126 offset:18432
ds_read_b64_tr_b16 v[100:101], v127 offset:16384
ds_read_b64_tr_b16 v[102:103], v127 offset:18432
s_waitcnt lgkmcnt(8)
s_add_u32 m0, s75, 65536
s_add_u32 s59, s72, 110592
buffer_load_dwordx4 v120, s[40:43], s59 offen offset:0 lds
buffer_load_dwordx4 v121, s[40:43], s59 offen offset:1024 lds
buffer_load_dwordx4 v122, s[40:43], s59 offen offset:2048 lds
buffer_load_dwordx4 v123, s[40:43], s59 offen offset:3072 lds
s_waitcnt vmcnt(33)
v_add_u32 v124, 0x10000, v124
v_add_u32 v125, 0x10000, v125
v_add_u32 v126, 0x10000, v126
v_add_u32 v127, 0x10000, v127
ds_read_b64_tr_b16 v[104:105], v124 offset:16384
ds_read_b64_tr_b16 v[106:107], v124 offset:18432
ds_read_b64_tr_b16 v[108:109], v125 offset:16384
ds_read_b64_tr_b16 v[110:111], v125 offset:18432
ds_read_b64_tr_b16 v[112:113], v126 offset:16384
ds_read_b64_tr_b16 v[114:115], v126 offset:18432
ds_read_b64_tr_b16 v[116:117], v127 offset:16384
ds_read_b64_tr_b16 v[118:119], v127 offset:18432
s_waitcnt lgkmcnt(8)
s_add_u32 m0, s75, 81920
s_add_u32 s72, s72, 147456
s_cmp_eq_u32 s72, 1179648
s_cselect_b32 s72, 0, s72
buffer_load_dwordx4 v120, s[40:43], s72 offen offset:0 lds
buffer_load_dwordx4 v121, s[40:43], s72 offen offset:1024 lds
buffer_load_dwordx4 v122, s[40:43], s72 offen offset:2048 lds
buffer_load_dwordx4 v123, s[40:43], s72 offen offset:3072 lds
s_waitcnt vmcnt(33)
v_add_u32 v124, 0xffff0000, v124
v_add_u32 v125, 0xffff0000, v125
v_add_u32 v126, 0xffff0000, v126
v_add_u32 v127, 0xffff0000, v127
ds_read_b64_tr_b16 v[208:209], v124 offset:32768
ds_read_b64_tr_b16 v[210:211], v124 offset:34816
ds_read_b64_tr_b16 v[212:213], v125 offset:32768
ds_read_b64_tr_b16 v[214:215], v125 offset:34816
ds_read_b64_tr_b16 v[216:217], v126 offset:32768
ds_read_b64_tr_b16 v[218:219], v126 offset:34816
ds_read_b64_tr_b16 v[220:221], v127 offset:32768
ds_read_b64_tr_b16 v[222:223], v127 offset:34816
s_waitcnt lgkmcnt(8)
s_add_u32 m0, s75, 147456
s_add_u32 s59, s72, 36864
buffer_load_dwordx4 v120, s[40:43], s59 offen offset:0 lds
buffer_load_dwordx4 v121, s[40:43], s59 offen offset:1024 lds
buffer_load_dwordx4 v122, s[40:43], s59 offen offset:2048 lds
buffer_load_dwordx4 v123, s[40:43], s59 offen offset:3072 lds
s_waitcnt vmcnt(33)
ds_read_b64_tr_b16 v[224:225], v124 offset:49152
ds_read_b64_tr_b16 v[226:227], v124 offset:51200
ds_read_b64_tr_b16 v[228:229], v125 offset:49152
ds_read_b64_tr_b16 v[230:231], v125 offset:51200
ds_read_b64_tr_b16 v[232:233], v126 offset:49152
ds_read_b64_tr_b16 v[234:235], v126 offset:51200
ds_read_b64_tr_b16 v[236:237], v127 offset:49152
ds_read_b64_tr_b16 v[238:239], v127 offset:51200
s_waitcnt lgkmcnt(8)
s_add_u32 m0, s75, 98304
s_add_u32 s59, s72, 73728
buffer_load_dwordx4 v120, s[40:43], s59 offen offset:0 lds
buffer_load_dwordx4 v121, s[40:43], s59 offen offset:1024 lds
buffer_load_dwordx4 v122, s[40:43], s59 offen offset:2048 lds
buffer_load_dwordx4 v123, s[40:43], s59 offen offset:3072 lds
s_waitcnt lgkmcnt(0)
s_add_u32 m0, s75, 114688
s_add_u32 s59, s72, 110592
buffer_load_dwordx4 v120, s[40:43], s59 offen offset:0 lds
buffer_load_dwordx4 v121, s[40:43], s59 offen offset:1024 lds
buffer_load_dwordx4 v122, s[40:43], s59 offen offset:2048 lds
buffer_load_dwordx4 v123, s[40:43], s59 offen offset:3072 lds
s_cmp_lg_u32 s3, 0
s_cbranch_scc1 L_nopoll
s_waitcnt vmcnt(24)
v_readfirstlane_b32 s58, v246
s_nop 3
s_cmp_ge_u32 s58, 32
s_cbranch_scc1 L_polled
s_lshl_b32 s58, s68, 5
v_mov_b32 v244, s58
L_poll:
buffer_load_dword v243, v244, s[28:31], 0 offen sc1
s_waitcnt vmcnt(0)
v_readfirstlane_b32 s58, v243
s_nop 3
s_cmp_ge_u32 s58, 32
s_cbranch_scc1 L_polled
s_sleep 1
s_branch L_poll
L_polled:
L_nopoll:
s_barrier
buffer_load_dwordx4 v[24:27], v128, s[36:39], s74 offen offset:0 sc1
buffer_load_dwordx4 v[28:31], v129, s[36:39], s74 offen offset:0 sc1
buffer_load_dwordx4 v[32:35], v130, s[36:39], s74 offen offset:0 sc1
buffer_load_dwordx4 v[36:39], v131, s[36:39], s74 offen offset:0 sc1
buffer_load_dwordx4 v[40:43], v128, s[36:39], s74 offen offset:1024 sc1
buffer_load_dwordx4 v[44:47], v129, s[36:39], s74 offen offset:1024 sc1
buffer_load_dwordx4 v[48:51], v130, s[36:39], s74 offen offset:1024 sc1
buffer_load_dwordx4 v[52:55], v131, s[36:39], s74 offen offset:1024 sc1
buffer_load_dwordx4 v[56:59], v128, s[36:39], s74 offen offset:2048 sc1
buffer_load_dwordx4 v[60:63], v129, s[36:39], s74 offen offset:2048 sc1
buffer_load_dwordx4 v[64:67], v130, s[36:39], s74 offen offset:2048 sc1
buffer_load_dwordx4 v[68:71], v131, s[36:39], s74 offen offset:2048 sc1
s_waitcnt vmcnt(11)
v_mfma_f32_16x16x32_bf16 v[144:147], a[192:195], v[24:27], 0
v_mfma_f32_16x16x32_bf16 v[160:163], a[196:199], v[24:27], 0
v_mfma_f32_16x16x32_bf16 v[176:179], a[200:203], v[24:27], 0
v_mfma_f32_16x16x32_bf16 v[192:195], a[204:207], v[24:27], 0
buffer_load_dwordx4 v[24:27], v128, s[36:39], s74 offen offset:3072 sc1
s_waitcnt vmcnt(11)
v_mfma_f32_16x16x32_bf16 v[148:151], a[192:195], v[28:31], 0
v_mfma_f32_16x16x32_bf16 v[164:167], a[196:199], v[28:31], 0
v_mfma_f32_16x16x32_bf16 v[180:183], a[200:203], v[28:31], 0
v_mfma_f32_16x16x32_bf16 v[196:199], a[204:207], v[28:31], 0
buffer_load_dwordx4 v[28:31], v129, s[36:39], s74 offen offset:3072 sc1
s_waitcnt vmcnt(11)
v_mfma_f32_16x16x32_bf16 v[152:155], a[192:195], v[32:35], 0
v_mfma_f32_16x16x32_bf16 v[168:171], a[196:199], v[32:35], 0
v_mfma_f32_16x16x32_bf16 v[184:187], a[200:203], v[32:35], 0
v_mfma_f32_16x16x32_bf16 v[200:203], a[204:207], v[32:35], 0
buffer_load_dwordx4 v[32:35], v130, s[36:39], s74 offen offset:3072 sc1
s_waitcnt vmcnt(11)
v_mfma_f32_16x16x32_bf16 v[156:159], a[192:195], v[36:39], 0
v_mfma_f32_16x16x32_bf16 v[172:175], a[196:199], v[36:39], 0
v_mfma_f32_16x16x32_bf16 v[188:191], a[200:203], v[36:39], 0
v_mfma_f32_16x16x32_bf16 v[204:207], a[204:207], v[36:39], 0
buffer_load_dwordx4 v[36:39], v131, s[36:39], s74 offen offset:3072 sc1
s_waitcnt vmcnt(11)
v_mfma_f32_16x16x32_bf16 v[144:147], a[208:211], v[40:43], v[144:147]
v_mfma_f32_16x16x32_bf16 v[160:163], a[212:215], v[40:43], v[160:163]
v_mfma_f32_16x16x32_bf16 v[176:179], a[216:219], v[40:43], v[176:179]
v_mfma_f32_16x16x32_bf16 v[192:195], a[220:223], v[40:43], v[192:195]
s_add_u32 s74, s74, 4096
s_and_b32 s74, s74, 0x7fff
buffer_load_dwordx4 v[40:43], v128, s[36:39], s74 offen offset:0 sc1
s_waitcnt vmcnt(11)
v_mfma_f32_16x16x32_bf16 v[148:151], a[208:211], v[44:47], v[148:151]
v_mfma_f32_16x16x32_bf16 v[164:167], a[212:215], v[44:47], v[164:167]
v_mfma_f32_16x16x32_bf16 v[180:183], a[216:219], v[44:47], v[180:183]
v_mfma_f32_16x16x32_bf16 v[196:199], a[220:223], v[44:47], v[196:199]
buffer_load_dwordx4 v[44:47], v129, s[36:39], s74 offen offset:0 sc1
s_waitcnt vmcnt(11)
v_mfma_f32_16x16x32_bf16 v[152:155], a[208:211], v[48:51], v[152:155]
v_mfma_f32_16x16x32_bf16 v[168:171], a[212:215], v[48:51], v[168:171]
v_mfma_f32_16x16x32_bf16 v[184:187], a[216:219], v[48:51], v[184:187]
v_mfma_f32_16x16x32_bf16 v[200:203], a[220:223], v[48:51], v[200:203]
buffer_load_dwordx4 v[48:51], v130, s[36:39], s74 offen offset:0 sc1
s_waitcnt vmcnt(11)
v_mfma_f32_16x16x32_bf16 v[156:159], a[208:211], v[52:55], v[156:159]
v_mfma_f32_16x16x32_bf16 v[172:175], a[212:215], v[52:55], v[172:175]
v_mfma_f32_16x16x32_bf16 v[188:191], a[216:219], v[52:55], v[188:191]
v_mfma_f32_16x16x32_bf16 v[204:207], a[220:223], v[52:55], v[204:207]
buffer_load_dwordx4 v[52:55], v131, s[36:39], s74 offen offset:0 sc1
s_waitcnt vmcnt(11)
v_mfma_f32_16x16x32_bf16 v[144:147], a[224:227], v[56:59], v[144:147]
v_mfma_f32_16x16x32_bf16 v[160:163], a[228:231], v[56:59], v[160:163]
v_mfma_f32_16x16x32_bf16 v[176:179], a[232:235], v[56:59], v[176:179]
v_mfma_f32_16x16x32_bf16 v[192:195], a[236:239], v[56:59], v[192:195]
buffer_load_dwordx4 v[56:59], v128, s[36:39], s74 offen offset:1024 sc1
s_waitcnt vmcnt(11)
v_mfma_f32_16x16x32_bf16 v[148:151], a[224:227], v[60:63], v[148:151]
v_mfma_f32_16x16x32_bf16 v[164:167], a[228:231], v[60:63], v[164:167]
v_mfma_f32_16x16x32_bf16 v[180:183], a[232:235], v[60:63], v[180:183]
v_mfma_f32_16x16x32_bf16 v[196:199], a[236:239], v[60:63], v[196:199]
buffer_load_dwordx4 v[60:63], v129, s[36:39], s74 offen offset:1024 sc1
s_waitcnt vmcnt(11)
v_mfma_f32_16x16x32_bf16 v[152:155], a[224:227], v[64:67], v[152:155]
v_mfma_f32_16x16x32_bf16 v[168:171], a[228:231], v[64:67], v[168:171]
v_mfma_f32_16x16x32_bf16 v[184:187], a[232:235], v[64:67], v[184:187]
v_mfma_f32_16x16x32_bf16 v[200:203], a[236:239], v[64:67], v[200:203]
buffer_load_dwordx4 v[64:67], v130, s[36:39], s74 offen offset:1024 sc1
s_waitcnt vmcnt(11)
v_mfma_f32_16x16x32_bf16 v[156:159], a[224:227], v[68:71], v[156:159]
v_mfma_f32_16x16x32_bf16 v[172:175], a[228:231], v[68:71], v[172:175]
v_mfma_f32_16x16x32_bf16 v[188:191], a[232:235], v[68:71], v[188:191]
v_mfma_f32_16x16x32_bf16 v[204:207], a[236:239], v[68:71], v[204:207]
buffer_load_dwordx4 v[68:71], v131, s[36:39], s74 offen offset:1024 sc1
s_waitcnt vmcnt(11)
v_mfma_f32_16x16x32_bf16 v[144:147], a[240:243], v[24:27], v[144:147]
v_mfma_f32_16x16x32_bf16 v[160:163], a[244:247], v[24:27], v[160:163]
v_mfma_f32_16x16x32_bf16 v[176:179], a[248:251], v[24:27], v[176:179]
v_mfma_f32_16x16x32_bf16 v[192:195], a[252:255], v[24:27], v[192:195]
buffer_load_dwordx4 v[24:27], v128, s[36:39], s74 offen offset:2048 sc1
s_waitcnt vmcnt(11)
v_mfma_f32_16x16x32_bf16 v[148:151], a[240:243], v[28:31], v[148:151]
v_mfma_f32_16x16x32_bf16 v[164:167], a[244:247], v[28:31], v[164:167]
v_mfma_f32_16x16x32_bf16 v[180:183], a[248:251], v[28:31], v[180:183]
v_mfma_f32_16x16x32_bf16 v[196:199], a[252:255], v[28:31], v[196:199]
buffer_load_dwordx4 v[28:31], v129, s[36:39], s74 offen offset:2048 sc1
s_waitcnt vmcnt(11)
v_mfma_f32_16x16x32_bf16 v[152:155], a[240:243], v[32:35], v[152:155]
v_mfma_f32_16x16x32_bf16 v[168:171], a[244:247], v[32:35], v[168:171]
v_mfma_f32_16x16x32_bf16 v[184:187], a[248:251], v[32:35], v[184:187]
v_mfma_f32_16x16x32_bf16 v[200:203], a[252:255], v[32:35], v[200:203]
buffer_load_dwordx4 v[32:35], v130, s[36:39], s74 offen offset:2048 sc1
s_waitcnt vmcnt(11)
v_mfma_f32_16x16x32_bf16 v[156:159], a[240:243], v[36:39], v[156:159]
v_mfma_f32_16x16x32_bf16 v[172:175], a[244:247], v[36:39], v[172:175]
v_mfma_f32_16x16x32_bf16 v[188:191], a[248:251], v[36:39], v[188:191]
v_mfma_f32_16x16x32_bf16 v[204:207], a[252:255], v[36:39], v[204:207]
buffer_load_dwordx4 v[36:39], v131, s[36:39], s74 offen offset:2048 sc1
s_waitcnt vmcnt(11)
v_mfma_f32_16x16x32_bf16 v[144:147], a[0:3], v[40:43], v[144:147]
v_mfma_f32_16x16x32_bf16 v[160:163], a[4:7], v[40:43], v[160:163]
v_mfma_f32_16x16x32_bf16 v[176:179], a[8:11], v[40:43], v[176:179]
v_mfma_f32_16x16x32_bf16 v[192:195], a[12:15], v[40:43], v[192:195]
buffer_load_dwordx4 v[40:43], v128, s[36:39], s74 offen offset:3072 sc1
s_waitcnt vmcnt(11)
v_mfma_f32_16x16x32_bf16 v[148:151], a[0:3], v[44:47], v[148:151]
v_mfma_f32_16x16x32_bf16 v[164:167], a[4:7], v[44:47], v[164:167]
v_mfma_f32_16x16x32_bf16 v[180:183], a[8:11], v[44:47], v[180:183]
v_mfma_f32_16x16x32_bf16 v[196:199], a[12:15], v[44:47], v[196:199]
buffer_load_dwordx4 v[44:47], v129, s[36:39], s74 offen offset:3072 sc1
s_waitcnt vmcnt(11)
v_mfma_f32_16x16x32_bf16 v[152:155], a[0:3], v[48:51], v[152:155]
v_mfma_f32_16x16x32_bf16 v[168:171], a[4:7], v[48:51], v[168:171]
v_mfma_f32_16x16x32_bf16 v[184:187], a[8:11], v[48:51], v[184:187]
v_mfma_f32_16x16x32_bf16 v[200:203], a[12:15], v[48:51], v[200:203]
buffer_load_dwordx4 v[48:51], v130, s[36:39], s74 offen offset:3072 sc1
s_waitcnt vmcnt(11)
v_mfma_f32_16x16x32_bf16 v[156:159], a[0:3], v[52:55], v[156:159]
v_mfma_f32_16x16x32_bf16 v[172:175], a[4:7], v[52:55], v[172:175]
v_mfma_f32_16x16x32_bf16 v[188:191], a[8:11], v[52:55], v[188:191]
v_mfma_f32_16x16x32_bf16 v[204:207], a[12:15], v[52:55], v[204:207]
buffer_load_dwordx4 v[52:55], v131, s[36:39], s74 offen offset:3072 sc1
s_waitcnt vmcnt(11)
v_mfma_f32_16x16x32_bf16 v[144:147], a[16:19], v[56:59], v[144:147]
v_mfma_f32_16x16x32_bf16 v[160:163], a[20:23], v[56:59], v[160:163]
v_mfma_f32_16x16x32_bf16 v[176:179], a[24:27], v[56:59], v[176:179]
v_mfma_f32_16x16x32_bf16 v[192:195], a[28:31], v[56:59], v[192:195]
s_add_u32 s74, s74, 4096
s_and_b32 s74, s74, 0x7fff
buffer_load_dwordx4 v[56:59], v128, s[36:39], s74 offen offset:0 sc1
s_waitcnt vmcnt(11)
v_mfma_f32_16x16x32_bf16 v[148:151], a[16:19], v[60:63], v[148:151]
v_mfma_f32_16x16x32_bf16 v[164:167], a[20:23], v[60:63], v[164:167]
v_mfma_f32_16x16x32_bf16 v[180:183], a[24:27], v[60:63], v[180:183]
v_mfma_f32_16x16x32_bf16 v[196:199], a[28:31], v[60:63], v[196:199]
buffer_load_dwordx4 v[60:63], v129, s[36:39], s74 offen offset:0 sc1
s_waitcnt vmcnt(11)
v_mfma_f32_16x16x32_bf16 v[152:155], a[16:19], v[64:67], v[152:155]
v_mfma_f32_16x16x32_bf16 v[168:171], a[20:23], v[64:67], v[168:171]
v_mfma_f32_16x16x32_bf16 v[184:187], a[24:27], v[64:67], v[184:187]
v_mfma_f32_16x16x32_bf16 v[200:203], a[28:31], v[64:67], v[200:203]
buffer_load_dwordx4 v[64:67], v130, s[36:39], s74 offen offset:0 sc1
s_waitcnt vmcnt(11)
v_mfma_f32_16x16x32_bf16 v[156:159], a[16:19], v[68:71], v[156:159]
v_mfma_f32_16x16x32_bf16 v[172:175], a[20:23], v[68:71], v[172:175]
v_mfma_f32_16x16x32_bf16 v[188:191], a[24:27], v[68:71], v[188:191]
v_mfma_f32_16x16x32_bf16 v[204:207], a[28:31], v[68:71], v[204:207]
buffer_load_dwordx4 v[68:71], v131, s[36:39], s74 offen offset:0 sc1
s_waitcnt vmcnt(11)
v_mfma_f32_16x16x32_bf16 v[144:147], a[32:35], v[24:27], v[144:147]
v_mfma_f32_16x16x32_bf16 v[160:163], a[36:39], v[24:27], v[160:163]
v_mfma_f32_16x16x32_bf16 v[176:179], a[40:43], v[24:27], v[176:179]
v_mfma_f32_16x16x32_bf16 v[192:195], a[44:47], v[24:27], v[192:195]
buffer_load_dwordx4 v[24:27], v128, s[36:39], s74 offen offset:1024 sc1
s_waitcnt vmcnt(11)
v_mfma_f32_16x16x32_bf16 v[148:151], a[32:35], v[28:31], v[148:151]
v_mfma_f32_16x16x32_bf16 v[164:167], a[36:39], v[28:31], v[164:167]
v_mfma_f32_16x16x32_bf16 v[180:183], a[40:43], v[28:31], v[180:183]
v_mfma_f32_16x16x32_bf16 v[196:199], a[44:47], v[28:31], v[196:199]
buffer_load_dwordx4 v[28:31], v129, s[36:39], s74 offen offset:1024 sc1
s_waitcnt vmcnt(11)
v_mfma_f32_16x16x32_bf16 v[152:155], a[32:35], v[32:35], v[152:155]
v_mfma_f32_16x16x32_bf16 v[168:171], a[36:39], v[32:35], v[168:171]
v_mfma_f32_16x16x32_bf16 v[184:187], a[40:43], v[32:35], v[184:187]
v_mfma_f32_16x16x32_bf16 v[200:203], a[44:47], v[32:35], v[200:203]
buffer_load_dwordx4 v[32:35], v130, s[36:39], s74 offen offset:1024 sc1
s_waitcnt vmcnt(11)
v_mfma_f32_16x16x32_bf16 v[156:159], a[32:35], v[36:39], v[156:159]
v_mfma_f32_16x16x32_bf16 v[172:175], a[36:39], v[36:39], v[172:175]
v_mfma_f32_16x16x32_bf16 v[188:191], a[40:43], v[36:39], v[188:191]
v_mfma_f32_16x16x32_bf16 v[204:207], a[44:47], v[36:39], v[204:207]
buffer_load_dwordx4 v[36:39], v131, s[36:39], s74 offen offset:1024 sc1
s_waitcnt vmcnt(11)
v_mfma_f32_16x16x32_bf16 v[144:147], a[48:51], v[40:43], v[144:147]
v_mfma_f32_16x16x32_bf16 v[160:163], a[52:55], v[40:43], v[160:163]
v_mfma_f32_16x16x32_bf16 v[176:179], a[56:59], v[40:43], v[176:179]
v_mfma_f32_16x16x32_bf16 v[192:195], a[60:63], v[40:43], v[192:195]
buffer_load_dwordx4 v[40:43], v128, s[36:39], s74 offen offset:2048 sc1
s_waitcnt vmcnt(11)
v_mfma_f32_16x16x32_bf16 v[148:151], a[48:51], v[44:47], v[148:151]
v_mfma_f32_16x16x32_bf16 v[164:167], a[52:55], v[44:47], v[164:167]
v_mfma_f32_16x16x32_bf16 v[180:183], a[56:59], v[44:47], v[180:183]
v_mfma_f32_16x16x32_bf16 v[196:199], a[60:63], v[44:47], v[196:199]
buffer_load_dwordx4 v[44:47], v129, s[36:39], s74 offen offset:2048 sc1
s_waitcnt vmcnt(11)
v_mfma_f32_16x16x32_bf16 v[152:155], a[48:51], v[48:51], v[152:155]
v_mfma_f32_16x16x32_bf16 v[168:171], a[52:55], v[48:51], v[168:171]
v_mfma_f32_16x16x32_bf16 v[184:187], a[56:59], v[48:51], v[184:187]
v_mfma_f32_16x16x32_bf16 v[200:203], a[60:63], v[48:51], v[200:203]
buffer_load_dwordx4 v[48:51], v130, s[36:39], s74 offen offset:2048 sc1
s_waitcnt vmcnt(11)
v_mfma_f32_16x16x32_bf16 v[156:159], a[48:51], v[52:55], v[156:159]
v_mfma_f32_16x16x32_bf16 v[172:175], a[52:55], v[52:55], v[172:175]
v_mfma_f32_16x16x32_bf16 v[188:191], a[56:59], v[52:55], v[188:191]
v_mfma_f32_16x16x32_bf16 v[204:207], a[60:63], v[52:55], v[204:207]
buffer_load_dwordx4 v[52:55], v131, s[36:39], s74 offen offset:2048 sc1
s_waitcnt vmcnt(11)
v_mfma_f32_16x16x32_bf16 v[144:147], a[64:67], v[56:59], v[144:147]
v_mfma_f32_16x16x32_bf16 v[160:163], a[68:71], v[56:59], v[160:163]
v_mfma_f32_16x16x32_bf16 v[176:179], a[72:75], v[56:59], v[176:179]
v_mfma_f32_16x16x32_bf16 v[192:195], a[76:79], v[56:59], v[192:195]
buffer_load_dwordx4 v[56:59], v128, s[36:39], s74 offen offset:3072 sc1
s_waitcnt vmcnt(11)
v_mfma_f32_16x16x32_bf16 v[148:151], a[64:67], v[60:63], v[148:151]
v_mfma_f32_16x16x32_bf16 v[164:167], a[68:71], v[60:63], v[164:167]
v_mfma_f32_16x16x32_bf16 v[180:183], a[72:75], v[60:63], v[180:183]
v_mfma_f32_16x16x32_bf16 v[196:199], a[76:79], v[60:63], v[196:199]
buffer_load_dwordx4 v[60:63], v129, s[36:39], s74 offen offset:3072 sc1
s_waitcnt vmcnt(11)
v_mfma_f32_16x16x32_bf16 v[152:155], a[64:67], v[64:67], v[152:155]
v_mfma_f32_16x16x32_bf16 v[168:171], a[68:71], v[64:67], v[168:171]
v_mfma_f32_16x16x32_bf16 v[184:187], a[72:75], v[64:67], v[184:187]
v_mfma_f32_16x16x32_bf16 v[200:203], a[76:79], v[64:67], v[200:203]
buffer_load_dwordx4 v[64:67], v130, s[36:39], s74 offen offset:3072 sc1
s_waitcnt vmcnt(11)
v_mfma_f32_16x16x32_bf16 v[156:159], a[64:67], v[68:71], v[156:159]
v_mfma_f32_16x16x32_bf16 v[172:175], a[68:71], v[68:71], v[172:175]
v_mfma_f32_16x16x32_bf16 v[188:191], a[72:75], v[68:71], v[188:191]
v_mfma_f32_16x16x32_bf16 v[204:207], a[76:79], v[68:71], v[204:207]
buffer_load_dwordx4 v[68:71], v131, s[36:39], s74 offen offset:3072 sc1
s_waitcnt vmcnt(11)
v_mfma_f32_16x16x32_bf16 v[144:147], a[80:83], v[24:27], v[144:147]
v_mfma_f32_16x16x32_bf16 v[160:163], a[84:87], v[24:27], v[160:163]
v_mfma_f32_16x16x32_bf16 v[176:179], a[88:91], v[24:27], v[176:179]
v_mfma_f32_16x16x32_bf16 v[192:195], a[92:95], v[24:27], v[192:195]
s_add_u32 s74, s74, 4096
s_and_b32 s74, s74, 0x7fff
buffer_load_dwordx4 v[24:27], v128, s[36:39], s74 offen offset:0 sc1
s_waitcnt vmcnt(11)
v_mfma_f32_16x16x32_bf16 v[148:151], a[80:83], v[28:31], v[148:151]
v_mfma_f32_16x16x32_bf16 v[164:167], a[84:87], v[28:31], v[164:167]
v_mfma_f32_16x16x32_bf16 v[180:183], a[88:91], v[28:31], v[180:183]
v_mfma_f32_16x16x32_bf16 v[196:199], a[92:95], v[28:31], v[196:199]
buffer_load_dwordx4 v[28:31], v129, s[36:39], s74 offen offset:0 sc1
s_waitcnt vmcnt(11)
v_mfma_f32_16x16x32_bf16 v[152:155], a[80:83], v[32:35], v[152:155]
v_mfma_f32_16x16x32_bf16 v[168:171], a[84:87], v[32:35], v[168:171]
v_mfma_f32_16x16x32_bf16 v[184:187], a[88:91], v[32:35], v[184:187]
v_mfma_f32_16x16x32_bf16 v[200:203], a[92:95], v[32:35], v[200:203]
buffer_load_dwordx4 v[32:35], v130, s[36:39], s74 offen offset:0 sc1
s_waitcnt vmcnt(11)
v_mfma_f32_16x16x32_bf16 v[156:159], a[80:83], v[36:39], v[156:159]
v_mfma_f32_16x16x32_bf16 v[172:175], a[84:87], v[36:39], v[172:175]
v_mfma_f32_16x16x32_bf16 v[188:191], a[88:91], v[36:39], v[188:191]
v_mfma_f32_16x16x32_bf16 v[204:207], a[92:95], v[36:39], v[204:207]
buffer_load_dwordx4 v[36:39], v131, s[36:39], s74 offen offset:0 sc1
s_waitcnt vmcnt(11)
v_mfma_f32_16x16x32_bf16 v[144:147], a[96:99], v[40:43], v[144:147]
v_mfma_f32_16x16x32_bf16 v[160:163], a[100:103], v[40:43], v[160:163]
v_mfma_f32_16x16x32_bf16 v[176:179], a[104:107], v[40:43], v[176:179]
v_mfma_f32_16x16x32_bf16 v[192:195], a[108:111], v[40:43], v[192:195]
buffer_load_dwordx4 v[40:43], v128, s[36:39], s74 offen offset:1024 sc1
s_waitcnt vmcnt(11)
v_mfma_f32_16x16x32_bf16 v[148:151], a[96:99], v[44:47], v[148:151]
v_mfma_f32_16x16x32_bf16 v[164:167], a[100:103], v[44:47], v[164:167]
v_mfma_f32_16x16x32_bf16 v[180:183], a[104:107], v[44:47], v[180:183]
v_mfma_f32_16x16x32_bf16 v[196:199], a[108:111], v[44:47], v[196:199]
buffer_load_dwordx4 v[44:47], v129, s[36:39], s74 offen offset:1024 sc1
s_waitcnt vmcnt(11)
v_mfma_f32_16x16x32_bf16 v[152:155], a[96:99], v[48:51], v[152:155]
v_mfma_f32_16x16x32_bf16 v[168:171], a[100:103], v[48:51], v[168:171]
v_mfma_f32_16x16x32_bf16 v[184:187], a[104:107], v[48:51], v[184:187]
v_mfma_f32_16x16x32_bf16 v[200:203], a[108:111], v[48:51], v[200:203]
buffer_load_dwordx4 v[48:51], v130, s[36:39], s74 offen offset:1024 sc1
s_waitcnt vmcnt(11)
v_mfma_f32_16x16x32_bf16 v[156:159], a[96:99], v[52:55], v[156:159]
v_mfma_f32_16x16x32_bf16 v[172:175], a[100:103], v[52:55], v[172:175]
v_mfma_f32_16x16x32_bf16 v[188:191], a[104:107], v[52:55], v[188:191]
v_mfma_f32_16x16x32_bf16 v[204:207], a[108:111], v[52:55], v[204:207]
buffer_load_dwordx4 v[52:55], v131, s[36:39], s74 offen offset:1024 sc1
s_waitcnt vmcnt(11)
v_mfma_f32_16x16x32_bf16 v[144:147], a[112:115], v[56:59], v[144:147]
v_mfma_f32_16x16x32_bf16 v[160:163], a[116:119], v[56:59], v[160:163]
v_mfma_f32_16x16x32_bf16 v[176:179], a[120:123], v[56:59], v[176:179]
v_mfma_f32_16x16x32_bf16 v[192:195], a[124:127], v[56:59], v[192:195]
buffer_load_dwordx4 v[56:59], v128, s[36:39], s74 offen offset:2048 sc1
s_waitcnt vmcnt(11)
v_mfma_f32_16x16x32_bf16 v[148:151], a[112:115], v[60:63], v[148:151]
v_mfma_f32_16x16x32_bf16 v[164:167], a[116:119], v[60:63], v[164:167]
v_mfma_f32_16x16x32_bf16 v[180:183], a[120:123], v[60:63], v[180:183]
v_mfma_f32_16x16x32_bf16 v[196:199], a[124:127], v[60:63], v[196:199]
buffer_load_dwordx4 v[60:63], v129, s[36:39], s74 offen offset:2048 sc1
s_waitcnt vmcnt(11)
v_mfma_f32_16x16x32_bf16 v[152:155], a[112:115], v[64:67], v[152:155]
v_mfma_f32_16x16x32_bf16 v[168:171], a[116:119], v[64:67], v[168:171]
v_mfma_f32_16x16x32_bf16 v[184:187], a[120:123], v[64:67], v[184:187]
v_mfma_f32_16x16x32_bf16 v[200:203], a[124:127], v[64:67], v[200:203]
buffer_load_dwordx4 v[64:67], v130, s[36:39], s74 offen offset:2048 sc1
s_waitcnt vmcnt(11)
v_mfma_f32_16x16x32_bf16 v[156:159], a[112:115], v[68:71], v[156:159]
v_mfma_f32_16x16x32_bf16 v[172:175], a[116:119], v[68:71], v[172:175]
v_mfma_f32_16x16x32_bf16 v[188:191], a[120:123], v[68:71], v[188:191]
v_mfma_f32_16x16x32_bf16 v[204:207], a[124:127], v[68:71], v[204:207]
buffer_load_dwordx4 v[68:71], v131, s[36:39], s74 offen offset:2048 sc1
s_waitcnt vmcnt(11)
v_mfma_f32_16x16x32_bf16 v[144:147], a[128:131], v[24:27], v[144:147]
v_mfma_f32_16x16x32_bf16 v[160:163], a[132:135], v[24:27], v[160:163]
v_mfma_f32_16x16x32_bf16 v[176:179], a[136:139], v[24:27], v[176:179]
v_mfma_f32_16x16x32_bf16 v[192:195], a[140:143], v[24:27], v[192:195]
buffer_load_dwordx4 v[24:27], v128, s[36:39], s74 offen offset:3072 sc1
s_waitcnt vmcnt(11)
v_mfma_f32_16x16x32_bf16 v[148:151], a[128:131], v[28:31], v[148:151]
v_mfma_f32_16x16x32_bf16 v[164:167], a[132:135], v[28:31], v[164:167]
v_mfma_f32_16x16x32_bf16 v[180:183], a[136:139], v[28:31], v[180:183]
v_mfma_f32_16x16x32_bf16 v[196:199], a[140:143], v[28:31], v[196:199]
buffer_load_dwordx4 v[28:31], v129, s[36:39], s74 offen offset:3072 sc1
s_waitcnt vmcnt(11)
v_mfma_f32_16x16x32_bf16 v[152:155], a[128:131], v[32:35], v[152:155]
v_mfma_f32_16x16x32_bf16 v[168:171], a[132:135], v[32:35], v[168:171]
v_mfma_f32_16x16x32_bf16 v[184:187], a[136:139], v[32:35], v[184:187]
v_mfma_f32_16x16x32_bf16 v[200:203], a[140:143], v[32:35], v[200:203]
buffer_load_dwordx4 v[32:35], v130, s[36:39], s74 offen offset:3072 sc1
s_waitcnt vmcnt(11)
v_mfma_f32_16x16x32_bf16 v[156:159], a[128:131], v[36:39], v[156:159]
v_mfma_f32_16x16x32_bf16 v[172:175], a[132:135], v[36:39], v[172:175]
v_mfma_f32_16x16x32_bf16 v[188:191], a[136:139], v[36:39], v[188:191]
v_mfma_f32_16x16x32_bf16 v[204:207], a[140:143], v[36:39], v[204:207]
buffer_load_dwordx4 v[36:39], v131, s[36:39], s74 offen offset:3072 sc1
s_waitcnt vmcnt(11)
v_mfma_f32_16x16x32_bf16 v[144:147], a[144:147], v[40:43], v[144:147]
v_mfma_f32_16x16x32_bf16 v[160:163], a[148:151], v[40:43], v[160:163]
v_mfma_f32_16x16x32_bf16 v[176:179], a[152:155], v[40:43], v[176:179]
v_mfma_f32_16x16x32_bf16 v[192:195], a[156:159], v[40:43], v[192:195]
s_add_u32 s74, s74, 4096
s_and_b32 s74, s74, 0x7fff
buffer_load_dwordx4 v[40:43], v128, s[36:39], s74 offen offset:0 sc1
s_waitcnt vmcnt(11)
v_mfma_f32_16x16x32_bf16 v[148:151], a[144:147], v[44:47], v[148:151]
v_mfma_f32_16x16x32_bf16 v[164:167], a[148:151], v[44:47], v[164:167]
v_mfma_f32_16x16x32_bf16 v[180:183], a[152:155], v[44:47], v[180:183]
v_mfma_f32_16x16x32_bf16 v[196:199], a[156:159], v[44:47], v[196:199]
buffer_load_dwordx4 v[44:47], v129, s[36:39], s74 offen offset:0 sc1
s_waitcnt vmcnt(11)
v_mfma_f32_16x16x32_bf16 v[152:155], a[144:147], v[48:51], v[152:155]
v_mfma_f32_16x16x32_bf16 v[168:171], a[148:151], v[48:51], v[168:171]
v_mfma_f32_16x16x32_bf16 v[184:187], a[152:155], v[48:51], v[184:187]
v_mfma_f32_16x16x32_bf16 v[200:203], a[156:159], v[48:51], v[200:203]
buffer_load_dwordx4 v[48:51], v130, s[36:39], s74 offen offset:0 sc1
s_waitcnt vmcnt(11)
v_mfma_f32_16x16x32_bf16 v[156:159], a[144:147], v[52:55], v[156:159]
v_mfma_f32_16x16x32_bf16 v[172:175], a[148:151], v[52:55], v[172:175]
v_mfma_f32_16x16x32_bf16 v[188:191], a[152:155], v[52:55], v[188:191]
v_mfma_f32_16x16x32_bf16 v[204:207], a[156:159], v[52:55], v[204:207]
buffer_load_dwordx4 v[52:55], v131, s[36:39], s74 offen offset:0 sc1
s_waitcnt vmcnt(11)
v_mfma_f32_16x16x32_bf16 v[144:147], a[160:163], v[56:59], v[144:147]
v_mfma_f32_16x16x32_bf16 v[160:163], a[164:167], v[56:59], v[160:163]
v_mfma_f32_16x16x32_bf16 v[176:179], a[168:171], v[56:59], v[176:179]
v_mfma_f32_16x16x32_bf16 v[192:195], a[172:175], v[56:59], v[192:195]
buffer_load_dwordx4 v[56:59], v128, s[36:39], s74 offen offset:1024 sc1
s_waitcnt vmcnt(11)
v_mfma_f32_16x16x32_bf16 v[148:151], a[160:163], v[60:63], v[148:151]
v_mfma_f32_16x16x32_bf16 v[164:167], a[164:167], v[60:63], v[164:167]
v_mfma_f32_16x16x32_bf16 v[180:183], a[168:171], v[60:63], v[180:183]
v_mfma_f32_16x16x32_bf16 v[196:199], a[172:175], v[60:63], v[196:199]
buffer_load_dwordx4 v[60:63], v129, s[36:39], s74 offen offset:1024 sc1
s_waitcnt vmcnt(11)
v_mfma_f32_16x16x32_bf16 v[152:155], a[160:163], v[64:67], v[152:155]
v_mfma_f32_16x16x32_bf16 v[168:171], a[164:167], v[64:67], v[168:171]
v_mfma_f32_16x16x32_bf16 v[184:187], a[168:171], v[64:67], v[184:187]
v_mfma_f32_16x16x32_bf16 v[200:203], a[172:175], v[64:67], v[200:203]
buffer_load_dwordx4 v[64:67], v130, s[36:39], s74 offen offset:1024 sc1
s_waitcnt vmcnt(11)
v_mfma_f32_16x16x32_bf16 v[156:159], a[160:163], v[68:71], v[156:159]
v_mfma_f32_16x16x32_bf16 v[172:175], a[164:167], v[68:71], v[172:175]
v_mfma_f32_16x16x32_bf16 v[188:191], a[168:171], v[68:71], v[188:191]
v_mfma_f32_16x16x32_bf16 v[204:207], a[172:175], v[68:71], v[204:207]
buffer_load_dwordx4 v[68:71], v131, s[36:39], s74 offen offset:1024 sc1
s_waitcnt vmcnt(11)
v_mfma_f32_16x16x32_bf16 v[144:147], a[176:179], v[24:27], v[144:147]
v_mfma_f32_16x16x32_bf16 v[160:163], a[180:183], v[24:27], v[160:163]
v_mfma_f32_16x16x32_bf16 v[176:179], a[184:187], v[24:27], v[176:179]
v_mfma_f32_16x16x32_bf16 v[192:195], a[188:191], v[24:27], v[192:195]
buffer_load_dwordx4 v[24:27], v128, s[36:39], s74 offen offset:2048 sc1
s_waitcnt vmcnt(11)
v_mfma_f32_16x16x32_bf16 v[148:151], a[176:179], v[28:31], v[148:151]
v_mfma_f32_16x16x32_bf16 v[164:167], a[180:183], v[28:31], v[164:167]
v_mfma_f32_16x16x32_bf16 v[180:183], a[184:187], v[28:31], v[180:183]
v_mfma_f32_16x16x32_bf16 v[196:199], a[188:191], v[28:31], v[196:199]
buffer_load_dwordx4 v[28:31], v129, s[36:39], s74 offen offset:2048 sc1
s_waitcnt vmcnt(11)
v_mfma_f32_16x16x32_bf16 v[152:155], a[176:179], v[32:35], v[152:155]
v_mfma_f32_16x16x32_bf16 v[168:171], a[180:183], v[32:35], v[168:171]
v_mfma_f32_16x16x32_bf16 v[184:187], a[184:187], v[32:35], v[184:187]
v_mfma_f32_16x16x32_bf16 v[200:203], a[188:191], v[32:35], v[200:203]
buffer_load_dwordx4 v[32:35], v130, s[36:39], s74 offen offset:2048 sc1
s_waitcnt vmcnt(11)
v_mfma_f32_16x16x32_bf16 v[156:159], a[176:179], v[36:39], v[156:159]
v_mfma_f32_16x16x32_bf16 v[172:175], a[180:183], v[36:39], v[172:175]
v_mfma_f32_16x16x32_bf16 v[188:191], a[184:187], v[36:39], v[188:191]
v_mfma_f32_16x16x32_bf16 v[204:207], a[188:191], v[36:39], v[204:207]
buffer_load_dwordx4 v[36:39], v131, s[36:39], s74 offen offset:2048 sc1
s_waitcnt vmcnt(11)
v_mfma_f32_16x16x32_bf16 v[144:147], v[8:11], v[40:43], v[144:147]
v_mfma_f32_16x16x32_bf16 v[160:163], v[12:15], v[40:43], v[160:163]
v_mfma_f32_16x16x32_bf16 v[176:179], v[16:19], v[40:43], v[176:179]
v_mfma_f32_16x16x32_bf16 v[192:195], v[20:23], v[40:43], v[192:195]
buffer_load_dwordx4 v[40:43], v128, s[36:39], s74 offen offset:3072 sc1
s_waitcnt vmcnt(11)
v_mfma_f32_16x16x32_bf16 v[148:151], v[8:11], v[44:47], v[148:151]
v_mfma_f32_16x16x32_bf16 v[164:167], v[12:15], v[44:47], v[164:167]
v_mfma_f32_16x16x32_bf16 v[180:183], v[16:19], v[44:47], v[180:183]
v_mfma_f32_16x16x32_bf16 v[196:199], v[20:23], v[44:47], v[196:199]
buffer_load_dwordx4 v[44:47], v129, s[36:39], s74 offen offset:3072 sc1
s_waitcnt vmcnt(11)
v_mfma_f32_16x16x32_bf16 v[152:155], v[8:11], v[48:51], v[152:155]
v_mfma_f32_16x16x32_bf16 v[168:171], v[12:15], v[48:51], v[168:171]
v_mfma_f32_16x16x32_bf16 v[184:187], v[16:19], v[48:51], v[184:187]
v_mfma_f32_16x16x32_bf16 v[200:203], v[20:23], v[48:51], v[200:203]
buffer_load_dwordx4 v[48:51], v130, s[36:39], s74 offen offset:3072 sc1
s_waitcnt vmcnt(11)
v_mfma_f32_16x16x32_bf16 v[156:159], v[8:11], v[52:55], v[156:159]
v_mfma_f32_16x16x32_bf16 v[172:175], v[12:15], v[52:55], v[172:175]
v_mfma_f32_16x16x32_bf16 v[188:191], v[16:19], v[52:55], v[188:191]
v_mfma_f32_16x16x32_bf16 v[204:207], v[20:23], v[52:55], v[204:207]
buffer_load_dwordx4 v[52:55], v131, s[36:39], s74 offen offset:3072 sc1
s_waitcnt vmcnt(11)
v_mfma_f32_16x16x32_bf16 v[144:147], v[72:75], v[56:59], v[144:147]
v_mfma_f32_16x16x32_bf16 v[160:163], v[76:79], v[56:59], v[160:163]
v_mfma_f32_16x16x32_bf16 v[176:179], v[80:83], v[56:59], v[176:179]
v_mfma_f32_16x16x32_bf16 v[192:195], v[84:87], v[56:59], v[192:195]
s_add_u32 s74, s74, 4096
s_and_b32 s74, s74, 0x7fff
buffer_load_dwordx4 v[56:59], v128, s[36:39], s74 offen offset:0 sc1
s_waitcnt vmcnt(11)
v_mfma_f32_16x16x32_bf16 v[148:151], v[72:75], v[60:63], v[148:151]
v_mfma_f32_16x16x32_bf16 v[164:167], v[76:79], v[60:63], v[164:167]
v_mfma_f32_16x16x32_bf16 v[180:183], v[80:83], v[60:63], v[180:183]
v_mfma_f32_16x16x32_bf16 v[196:199], v[84:87], v[60:63], v[196:199]
buffer_load_dwordx4 v[60:63], v129, s[36:39], s74 offen offset:0 sc1
s_waitcnt vmcnt(11)
v_mfma_f32_16x16x32_bf16 v[152:155], v[72:75], v[64:67], v[152:155]
v_mfma_f32_16x16x32_bf16 v[168:171], v[76:79], v[64:67], v[168:171]
v_mfma_f32_16x16x32_bf16 v[184:187], v[80:83], v[64:67], v[184:187]
v_mfma_f32_16x16x32_bf16 v[200:203], v[84:87], v[64:67], v[200:203]
buffer_load_dwordx4 v[64:67], v130, s[36:39], s74 offen offset:0 sc1
s_waitcnt vmcnt(11)
v_mfma_f32_16x16x32_bf16 v[156:159], v[72:75], v[68:71], v[156:159]
v_mfma_f32_16x16x32_bf16 v[172:175], v[76:79], v[68:71], v[172:175]
v_mfma_f32_16x16x32_bf16 v[188:191], v[80:83], v[68:71], v[188:191]
v_mfma_f32_16x16x32_bf16 v[204:207], v[84:87], v[68:71], v[204:207]
buffer_load_dwordx4 v[68:71], v131, s[36:39], s74 offen offset:0 sc1
s_waitcnt vmcnt(11)
v_mfma_f32_16x16x32_bf16 v[144:147], v[88:91], v[24:27], v[144:147]
v_mfma_f32_16x16x32_bf16 v[160:163], v[92:95], v[24:27], v[160:163]
v_mfma_f32_16x16x32_bf16 v[176:179], v[96:99], v[24:27], v[176:179]
v_mfma_f32_16x16x32_bf16 v[192:195], v[100:103], v[24:27], v[192:195]
buffer_load_dwordx4 v[24:27], v128, s[36:39], s74 offen offset:1024 sc1
s_waitcnt vmcnt(11)
v_mfma_f32_16x16x32_bf16 v[148:151], v[88:91], v[28:31], v[148:151]
v_mfma_f32_16x16x32_bf16 v[164:167], v[92:95], v[28:31], v[164:167]
v_mfma_f32_16x16x32_bf16 v[180:183], v[96:99], v[28:31], v[180:183]
v_mfma_f32_16x16x32_bf16 v[196:199], v[100:103], v[28:31], v[196:199]
buffer_load_dwordx4 v[28:31], v129, s[36:39], s74 offen offset:1024 sc1
s_waitcnt vmcnt(11)
v_mfma_f32_16x16x32_bf16 v[152:155], v[88:91], v[32:35], v[152:155]
v_mfma_f32_16x16x32_bf16 v[168:171], v[92:95], v[32:35], v[168:171]
v_mfma_f32_16x16x32_bf16 v[184:187], v[96:99], v[32:35], v[184:187]
v_mfma_f32_16x16x32_bf16 v[200:203], v[100:103], v[32:35], v[200:203]
buffer_load_dwordx4 v[32:35], v130, s[36:39], s74 offen offset:1024 sc1
s_waitcnt vmcnt(11)
v_mfma_f32_16x16x32_bf16 v[156:159], v[88:91], v[36:39], v[156:159]
v_mfma_f32_16x16x32_bf16 v[172:175], v[92:95], v[36:39], v[172:175]
v_mfma_f32_16x16x32_bf16 v[188:191], v[96:99], v[36:39], v[188:191]
v_mfma_f32_16x16x32_bf16 v[204:207], v[100:103], v[36:39], v[204:207]
buffer_load_dwordx4 v[36:39], v131, s[36:39], s74 offen offset:1024 sc1
s_waitcnt vmcnt(11)
v_mfma_f32_16x16x32_bf16 v[144:147], v[104:107], v[40:43], v[144:147]
v_mfma_f32_16x16x32_bf16 v[160:163], v[108:111], v[40:43], v[160:163]
v_mfma_f32_16x16x32_bf16 v[176:179], v[112:115], v[40:43], v[176:179]
v_mfma_f32_16x16x32_bf16 v[192:195], v[116:119], v[40:43], v[192:195]
buffer_load_dwordx4 v[40:43], v128, s[36:39], s74 offen offset:2048 sc1
s_waitcnt vmcnt(11)
v_mfma_f32_16x16x32_bf16 v[148:151], v[104:107], v[44:47], v[148:151]
v_mfma_f32_16x16x32_bf16 v[164:167], v[108:111], v[44:47], v[164:167]
v_mfma_f32_16x16x32_bf16 v[180:183], v[112:115], v[44:47], v[180:183]
v_mfma_f32_16x16x32_bf16 v[196:199], v[116:119], v[44:47], v[196:199]
buffer_load_dwordx4 v[44:47], v129, s[36:39], s74 offen offset:2048 sc1
s_waitcnt vmcnt(11)
v_mfma_f32_16x16x32_bf16 v[152:155], v[104:107], v[48:51], v[152:155]
v_mfma_f32_16x16x32_bf16 v[168:171], v[108:111], v[48:51], v[168:171]
v_mfma_f32_16x16x32_bf16 v[184:187], v[112:115], v[48:51], v[184:187]
v_mfma_f32_16x16x32_bf16 v[200:203], v[116:119], v[48:51], v[200:203]
buffer_load_dwordx4 v[48:51], v130, s[36:39], s74 offen offset:2048 sc1
s_waitcnt vmcnt(11)
v_mfma_f32_16x16x32_bf16 v[156:159], v[104:107], v[52:55], v[156:159]
v_mfma_f32_16x16x32_bf16 v[172:175], v[108:111], v[52:55], v[172:175]
v_mfma_f32_16x16x32_bf16 v[188:191], v[112:115], v[52:55], v[188:191]
v_mfma_f32_16x16x32_bf16 v[204:207], v[116:119], v[52:55], v[204:207]
buffer_load_dwordx4 v[52:55], v131, s[36:39], s74 offen offset:2048 sc1
v_add_u32 v124, 0x10000, v124
v_add_u32 v125, 0x10000, v125
v_add_u32 v126, 0x10000, v126
v_add_u32 v127, 0x10000, v127
ds_read_b64_tr_b16 a[192:193], v124 offset:0
ds_read_b64_tr_b16 a[194:195], v124 offset:2048
ds_read_b64_tr_b16 a[196:197], v125 offset:0
ds_read_b64_tr_b16 a[198:199], v125 offset:2048
ds_read_b64_tr_b16 a[200:201], v126 offset:0
ds_read_b64_tr_b16 a[202:203], v126 offset:2048
ds_read_b64_tr_b16 a[204:205], v127 offset:0
ds_read_b64_tr_b16 a[206:207], v127 offset:2048
s_waitcnt vmcnt(11)
v_mfma_f32_16x16x32_bf16 v[144:147], v[208:211], v[56:59], v[144:147]
v_mfma_f32_16x16x32_bf16 v[160:163], v[212:215], v[56:59], v[160:163]
v_mfma_f32_16x16x32_bf16 v[176:179], v[216:219], v[56:59], v[176:179]
v_mfma_f32_16x16x32_bf16 v[192:195], v[220:223], v[56:59], v[192:195]
buffer_load_dwordx4 v[56:59], v128, s[36:39], s74 offen offset:3072 sc1
s_waitcnt vmcnt(11)
v_mfma_f32_16x16x32_bf16 v[148:151], v[208:211], v[60:63], v[148:151]
v_mfma_f32_16x16x32_bf16 v[164:167], v[212:215], v[60:63], v[164:167]
v_mfma_f32_16x16x32_bf16 v[180:183], v[216:219], v[60:63], v[180:183]
v_mfma_f32_16x16x32_bf16 v[196:199], v[220:223], v[60:63], v[196:199]
buffer_load_dwordx4 v[60:63], v129, s[36:39], s74 offen offset:3072 sc1
s_waitcnt vmcnt(11)
v_mfma_f32_16x16x32_bf16 v[152:155], v[208:211], v[64:67], v[152:155]
v_mfma_f32_16x16x32_bf16 v[168:171], v[212:215], v[64:67], v[168:171]
v_mfma_f32_16x16x32_bf16 v[184:187], v[216:219], v[64:67], v[184:187]
v_mfma_f32_16x16x32_bf16 v[200:203], v[220:223], v[64:67], v[200:203]
buffer_load_dwordx4 v[64:67], v130, s[36:39], s74 offen offset:3072 sc1
s_waitcnt vmcnt(11)
v_mfma_f32_16x16x32_bf16 v[156:159], v[208:211], v[68:71], v[156:159]
v_mfma_f32_16x16x32_bf16 v[172:175], v[212:215], v[68:71], v[172:175]
v_mfma_f32_16x16x32_bf16 v[188:191], v[216:219], v[68:71], v[188:191]
v_mfma_f32_16x16x32_bf16 v[204:207], v[220:223], v[68:71], v[204:207]
buffer_load_dwordx4 v[68:71], v131, s[36:39], s74 offen offset:3072 sc1
v_add_u32 v124, 0xfffe0000, v124
v_add_u32 v125, 0xfffe0000, v125
v_add_u32 v126, 0xfffe0000, v126
v_add_u32 v127, 0xfffe0000, v127
ds_read_b64_tr_b16 a[208:209], v124 offset:0
ds_read_b64_tr_b16 a[210:211], v124 offset:2048
ds_read_b64_tr_b16 a[212:213], v125 offset:0
ds_read_b64_tr_b16 a[214:215], v125 offset:2048
ds_read_b64_tr_b16 a[216:217], v126 offset:0
ds_read_b64_tr_b16 a[218:219], v126 offset:2048
ds_read_b64_tr_b16 a[220:221], v127 offset:0
ds_read_b64_tr_b16 a[222:223], v127 offset:2048
s_waitcnt vmcnt(11)
v_mfma_f32_16x16x32_bf16 v[144:147], v[224:227], v[24:27], v[144:147]
v_mfma_f32_16x16x32_bf16 v[160:163], v[228:231], v[24:27], v[160:163]
v_mfma_f32_16x16x32_bf16 v[176:179], v[232:235], v[24:27], v[176:179]
v_mfma_f32_16x16x32_bf16 v[192:195], v[236:239], v[24:27], v[192:195]
s_add_u32 s74, s74, 4096
s_and_b32 s74, s74, 0x7fff
buffer_load_dwordx4 v[24:27], v128, s[36:39], s74 offen offset:0 sc1
s_waitcnt vmcnt(11)
v_mfma_f32_16x16x32_bf16 v[148:151], v[224:227], v[28:31], v[148:151]
v_mfma_f32_16x16x32_bf16 v[164:167], v[228:231], v[28:31], v[164:167]
v_mfma_f32_16x16x32_bf16 v[180:183], v[232:235], v[28:31], v[180:183]
v_mfma_f32_16x16x32_bf16 v[196:199], v[236:239], v[28:31], v[196:199]
buffer_load_dwordx4 v[28:31], v129, s[36:39], s74 offen offset:0 sc1
s_waitcnt vmcnt(11)
v_mfma_f32_16x16x32_bf16 v[152:155], v[224:227], v[32:35], v[152:155]
v_mfma_f32_16x16x32_bf16 v[168:171], v[228:231], v[32:35], v[168:171]
v_mfma_f32_16x16x32_bf16 v[184:187], v[232:235], v[32:35], v[184:187]
v_mfma_f32_16x16x32_bf16 v[200:203], v[236:239], v[32:35], v[200:203]
buffer_load_dwordx4 v[32:35], v130, s[36:39], s74 offen offset:0 sc1
s_waitcnt vmcnt(11)
v_mfma_f32_16x16x32_bf16 v[156:159], v[224:227], v[36:39], v[156:159]
v_mfma_f32_16x16x32_bf16 v[172:175], v[228:231], v[36:39], v[172:175]
v_mfma_f32_16x16x32_bf16 v[188:191], v[232:235], v[36:39], v[188:191]
v_mfma_f32_16x16x32_bf16 v[204:207], v[236:239], v[36:39], v[204:207]
buffer_load_dwordx4 v[36:39], v131, s[36:39], s74 offen offset:0 sc1
ds_read_b64_tr_b16 a[224:225], v124 offset:16384
ds_read_b64_tr_b16 a[226:227], v124 offset:18432
ds_read_b64_tr_b16 a[228:229], v125 offset:16384
ds_read_b64_tr_b16 a[230:231], v125 offset:18432
ds_read_b64_tr_b16 a[232:233], v126 offset:16384
ds_read_b64_tr_b16 a[234:235], v126 offset:18432
ds_read_b64_tr_b16 a[236:237], v127 offset:16384
ds_read_b64_tr_b16 a[238:239], v127 offset:18432
s_waitcnt lgkmcnt(15)
s_waitcnt vmcnt(11)
v_mfma_f32_16x16x32_bf16 v[144:147], a[192:195], v[40:43], v[144:147]
v_mfma_f32_16x16x32_bf16 v[160:163], a[196:199], v[40:43], v[160:163]
v_mfma_f32_16x16x32_bf16 v[176:179], a[200:203], v[40:43], v[176:179]
v_mfma_f32_16x16x32_bf16 v[192:195], a[204:207], v[40:43], v[192:195]
buffer_load_dwordx4 v[40:43], v128, s[36:39], s74 offen offset:1024 sc1
s_waitcnt vmcnt(11)
v_mfma_f32_16x16x32_bf16 v[148:151], a[192:195], v[44:47], v[148:151]
v_mfma_f32_16x16x32_bf16 v[164:167], a[196:199], v[44:47], v[164:167]
v_mfma_f32_16x16x32_bf16 v[180:183], a[200:203], v[44:47], v[180:183]
v_mfma_f32_16x16x32_bf16 v[196:199], a[204:207], v[44:47], v[196:199]
buffer_load_dwordx4 v[44:47], v129, s[36:39], s74 offen offset:1024 sc1
s_waitcnt vmcnt(11)
v_mfma_f32_16x16x32_bf16 v[152:155], a[192:195], v[48:51], v[152:155]
v_mfma_f32_16x16x32_bf16 v[168:171], a[196:199], v[48:51], v[168:171]
v_mfma_f32_16x16x32_bf16 v[184:187], a[200:203], v[48:51], v[184:187]
v_mfma_f32_16x16x32_bf16 v[200:203], a[204:207], v[48:51], v[200:203]
buffer_load_dwordx4 v[48:51], v130, s[36:39], s74 offen offset:1024 sc1
s_waitcnt vmcnt(11)
v_mfma_f32_16x16x32_bf16 v[156:159], a[192:195], v[52:55], v[156:159]
v_mfma_f32_16x16x32_bf16 v[172:175], a[196:199], v[52:55], v[172:175]
v_mfma_f32_16x16x32_bf16 v[188:191], a[200:203], v[52:55], v[188:191]
v_mfma_f32_16x16x32_bf16 v[204:207], a[204:207], v[52:55], v[204:207]
buffer_load_dwordx4 v[52:55], v131, s[36:39], s74 offen offset:1024 sc1
ds_read_b64_tr_b16 a[240:241], v124 offset:32768
ds_read_b64_tr_b16 a[242:243], v124 offset:34816
ds_read_b64_tr_b16 a[244:245], v125 offset:32768
ds_read_b64_tr_b16 a[246:247], v125 offset:34816
ds_read_b64_tr_b16 a[248:249], v126 offset:32768
ds_read_b64_tr_b16 a[250:251], v126 offset:34816
ds_read_b64_tr_b16 a[252:253], v127 offset:32768
ds_read_b64_tr_b16 a[254:255], v127 offset:34816
s_waitcnt lgkmcnt(15)
s_waitcnt vmcnt(11)
v_mfma_f32_16x16x32_bf16 v[144:147], a[208:211], v[56:59], v[144:147]
v_mfma_f32_16x16x32_bf16 v[160:163], a[212:215], v[56:59], v[160:163]
v_mfma_f32_16x16x32_bf16 v[176:179], a[216:219], v[56:59], v[176:179]
v_mfma_f32_16x16x32_bf16 v[192:195], a[220:223], v[56:59], v[192:195]
buffer_load_dwordx4 v[56:59], v128, s[36:39], s74 offen offset:2048 sc1
s_waitcnt vmcnt(11)
v_mfma_f32_16x16x32_bf16 v[148:151], a[208:211], v[60:63], v[148:151]
v_mfma_f32_16x16x32_bf16 v[164:167], a[212:215], v[60:63], v[164:167]
v_mfma_f32_16x16x32_bf16 v[180:183], a[216:219], v[60:63], v[180:183]
v_mfma_f32_16x16x32_bf16 v[196:199], a[220:223], v[60:63], v[196:199]
buffer_load_dwordx4 v[60:63], v129, s[36:39], s74 offen offset:2048 sc1
s_waitcnt vmcnt(11)
v_mfma_f32_16x16x32_bf16 v[152:155], a[208:211], v[64:67], v[152:155]
v_mfma_f32_16x16x32_bf16 v[168:171], a[212:215], v[64:67], v[168:171]
v_mfma_f32_16x16x32_bf16 v[184:187], a[216:219], v[64:67], v[184:187]
v_mfma_f32_16x16x32_bf16 v[200:203], a[220:223], v[64:67], v[200:203]
buffer_load_dwordx4 v[64:67], v130, s[36:39], s74 offen offset:2048 sc1
s_waitcnt vmcnt(11)
v_mfma_f32_16x16x32_bf16 v[156:159], a[208:211], v[68:71], v[156:159]
v_mfma_f32_16x16x32_bf16 v[172:175], a[212:215], v[68:71], v[172:175]
v_mfma_f32_16x16x32_bf16 v[188:191], a[216:219], v[68:71], v[188:191]
v_mfma_f32_16x16x32_bf16 v[204:207], a[220:223], v[68:71], v[204:207]
buffer_load_dwordx4 v[68:71], v131, s[36:39], s74 offen offset:2048 sc1
ds_read_b64_tr_b16 a[0:1], v124 offset:49152
ds_read_b64_tr_b16 a[2:3], v124 offset:51200
ds_read_b64_tr_b16 a[4:5], v125 offset:49152
ds_read_b64_tr_b16 a[6:7], v125 offset:51200
ds_read_b64_tr_b16 a[8:9], v126 offset:49152
ds_read_b64_tr_b16 a[10:11], v126 offset:51200
ds_read_b64_tr_b16 a[12:13], v127 offset:49152
ds_read_b64_tr_b16 a[14:15], v127 offset:51200
s_waitcnt lgkmcnt(15)
s_waitcnt vmcnt(11)
v_mfma_f32_16x16x32_bf16 v[144:147], a[224:227], v[24:27], v[144:147]
v_mfma_f32_16x16x32_bf16 v[160:163], a[228:231], v[24:27], v[160:163]
v_mfma_f32_16x16x32_bf16 v[176:179], a[232:235], v[24:27], v[176:179]
v_mfma_f32_16x16x32_bf16 v[192:195], a[236:239], v[24:27], v[192:195]
buffer_load_dwordx4 v[24:27], v128, s[36:39], s74 offen offset:3072 sc1
s_waitcnt vmcnt(11)
v_mfma_f32_16x16x32_bf16 v[148:151], a[224:227], v[28:31], v[148:151]
v_mfma_f32_16x16x32_bf16 v[164:167], a[228:231], v[28:31], v[164:167]
v_mfma_f32_16x16x32_bf16 v[180:183], a[232:235], v[28:31], v[180:183]
v_mfma_f32_16x16x32_bf16 v[196:199], a[236:239], v[28:31], v[196:199]
buffer_load_dwordx4 v[28:31], v129, s[36:39], s74 offen offset:3072 sc1
s_waitcnt vmcnt(11)
v_mfma_f32_16x16x32_bf16 v[152:155], a[224:227], v[32:35], v[152:155]
v_mfma_f32_16x16x32_bf16 v[168:171], a[228:231], v[32:35], v[168:171]
v_mfma_f32_16x16x32_bf16 v[184:187], a[232:235], v[32:35], v[184:187]
v_mfma_f32_16x16x32_bf16 v[200:203], a[236:239], v[32:35], v[200:203]
buffer_load_dwordx4 v[32:35], v130, s[36:39], s74 offen offset:3072 sc1
s_waitcnt vmcnt(11)
v_mfma_f32_16x16x32_bf16 v[156:159], a[224:227], v[36:39], v[156:159]
v_mfma_f32_16x16x32_bf16 v[172:175], a[228:231], v[36:39], v[172:175]
v_mfma_f32_16x16x32_bf16 v[188:191], a[232:235], v[36:39], v[188:191]
v_mfma_f32_16x16x32_bf16 v[204:207], a[236:239], v[36:39], v[204:207]
buffer_load_dwordx4 v[36:39], v131, s[36:39], s74 offen offset:3072 sc1
v_add_u32 v124, 0x10000, v124
v_add_u32 v125, 0x10000, v125
v_add_u32 v126, 0x10000, v126
v_add_u32 v127, 0x10000, v127
ds_read_b64_tr_b16 a[16:17], v124 offset:0
ds_read_b64_tr_b16 a[18:19], v124 offset:2048
ds_read_b64_tr_b16 a[20:21], v125 offset:0
ds_read_b64_tr_b16 a[22:23], v125 offset:2048
ds_read_b64_tr_b16 a[24:25], v126 offset:0
ds_read_b64_tr_b16 a[26:27], v126 offset:2048
ds_read_b64_tr_b16 a[28:29], v127 offset:0
ds_read_b64_tr_b16 a[30:31], v127 offset:2048
s_waitcnt lgkmcnt(15)
s_waitcnt vmcnt(11)
v_mfma_f32_16x16x32_bf16 v[144:147], a[240:243], v[40:43], v[144:147]
v_mfma_f32_16x16x32_bf16 v[160:163], a[244:247], v[40:43], v[160:163]
v_mfma_f32_16x16x32_bf16 v[176:179], a[248:251], v[40:43], v[176:179]
v_mfma_f32_16x16x32_bf16 v[192:195], a[252:255], v[40:43], v[192:195]
s_add_u32 s74, s74, 4096
s_and_b32 s74, s74, 0x7fff
buffer_load_dwordx4 v[40:43], v128, s[36:39], s74 offen offset:0 sc1
s_waitcnt vmcnt(11)
v_mfma_f32_16x16x32_bf16 v[148:151], a[240:243], v[44:47], v[148:151]
v_mfma_f32_16x16x32_bf16 v[164:167], a[244:247], v[44:47], v[164:167]
v_mfma_f32_16x16x32_bf16 v[180:183], a[248:251], v[44:47], v[180:183]
v_mfma_f32_16x16x32_bf16 v[196:199], a[252:255], v[44:47], v[196:199]
buffer_load_dwordx4 v[44:47], v129, s[36:39], s74 offen offset:0 sc1
s_waitcnt vmcnt(11)
v_mfma_f32_16x16x32_bf16 v[152:155], a[240:243], v[48:51], v[152:155]
v_mfma_f32_16x16x32_bf16 v[168:171], a[244:247], v[48:51], v[168:171]
v_mfma_f32_16x16x32_bf16 v[184:187], a[248:251], v[48:51], v[184:187]
v_mfma_f32_16x16x32_bf16 v[200:203], a[252:255], v[48:51], v[200:203]
buffer_load_dwordx4 v[48:51], v130, s[36:39], s74 offen offset:0 sc1
s_waitcnt vmcnt(11)
v_mfma_f32_16x16x32_bf16 v[156:159], a[240:243], v[52:55], v[156:159]
v_mfma_f32_16x16x32_bf16 v[172:175], a[244:247], v[52:55], v[172:175]
v_mfma_f32_16x16x32_bf16 v[188:191], a[248:251], v[52:55], v[188:191]
v_mfma_f32_16x16x32_bf16 v[204:207], a[252:255], v[52:55], v[204:207]
buffer_load_dwordx4 v[52:55], v131, s[36:39], s74 offen offset:0 sc1
ds_read_b64_tr_b16 a[32:33], v124 offset:16384
ds_read_b64_tr_b16 a[34:35], v124 offset:18432
ds_read_b64_tr_b16 a[36:37], v125 offset:16384
ds_read_b64_tr_b16 a[38:39], v125 offset:18432
ds_read_b64_tr_b16 a[40:41], v126 offset:16384
ds_read_b64_tr_b16 a[42:43], v126 offset:18432
ds_read_b64_tr_b16 a[44:45], v127 offset:16384
ds_read_b64_tr_b16 a[46:47], v127 offset:18432
s_waitcnt lgkmcnt(15)
s_waitcnt vmcnt(11)
v_mfma_f32_16x16x32_bf16 v[144:147], a[0:3], v[56:59], v[144:147]
v_mfma_f32_16x16x32_bf16 v[160:163], a[4:7], v[56:59], v[160:163]
v_mfma_f32_16x16x32_bf16 v[176:179], a[8:11], v[56:59], v[176:179]
v_mfma_f32_16x16x32_bf16 v[192:195], a[12:15], v[56:59], v[192:195]
buffer_load_dwordx4 v[56:59], v128, s[36:39], s74 offen offset:1024 sc1
s_waitcnt vmcnt(11)
v_mfma_f32_16x16x32_bf16 v[148:151], a[0:3], v[60:63], v[148:151]
v_mfma_f32_16x16x32_bf16 v[164:167], a[4:7], v[60:63], v[164:167]
v_mfma_f32_16x16x32_bf16 v[180:183], a[8:11], v[60:63], v[180:183]
v_mfma_f32_16x16x32_bf16 v[196:199], a[12:15], v[60:63], v[196:199]
buffer_load_dwordx4 v[60:63], v129, s[36:39], s74 offen offset:1024 sc1
s_waitcnt vmcnt(11)
v_mfma_f32_16x16x32_bf16 v[152:155], a[0:3], v[64:67], v[152:155]
v_mfma_f32_16x16x32_bf16 v[168:171], a[4:7], v[64:67], v[168:171]
v_mfma_f32_16x16x32_bf16 v[184:187], a[8:11], v[64:67], v[184:187]
v_mfma_f32_16x16x32_bf16 v[200:203], a[12:15], v[64:67], v[200:203]
buffer_load_dwordx4 v[64:67], v130, s[36:39], s74 offen offset:1024 sc1
s_waitcnt vmcnt(11)
v_mfma_f32_16x16x32_bf16 v[156:159], a[0:3], v[68:71], v[156:159]
v_mfma_f32_16x16x32_bf16 v[172:175], a[4:7], v[68:71], v[172:175]
v_mfma_f32_16x16x32_bf16 v[188:191], a[8:11], v[68:71], v[188:191]
v_mfma_f32_16x16x32_bf16 v[204:207], a[12:15], v[68:71], v[204:207]
buffer_load_dwordx4 v[68:71], v131, s[36:39], s74 offen offset:1024 sc1
v_add_u32 v124, 0x10000, v124
v_add_u32 v125, 0x10000, v125
v_add_u32 v126, 0x10000, v126
v_add_u32 v127, 0x10000, v127
ds_read_b64_tr_b16 a[48:49], v124 offset:16384
ds_read_b64_tr_b16 a[50:51], v124 offset:18432
ds_read_b64_tr_b16 a[52:53], v125 offset:16384
ds_read_b64_tr_b16 a[54:55], v125 offset:18432
ds_read_b64_tr_b16 a[56:57], v126 offset:16384
ds_read_b64_tr_b16 a[58:59], v126 offset:18432
ds_read_b64_tr_b16 a[60:61], v127 offset:16384
ds_read_b64_tr_b16 a[62:63], v127 offset:18432
s_waitcnt lgkmcnt(15)
s_waitcnt vmcnt(11)
v_mfma_f32_16x16x32_bf16 v[144:147], a[16:19], v[24:27], v[144:147]
v_mfma_f32_16x16x32_bf16 v[160:163], a[20:23], v[24:27], v[160:163]
v_mfma_f32_16x16x32_bf16 v[176:179], a[24:27], v[24:27], v[176:179]
v_mfma_f32_16x16x32_bf16 v[192:195], a[28:31], v[24:27], v[192:195]
buffer_load_dwordx4 v[24:27], v128, s[36:39], s74 offen offset:2048 sc1
s_waitcnt vmcnt(11)
v_mfma_f32_16x16x32_bf16 v[148:151], a[16:19], v[28:31], v[148:151]
v_mfma_f32_16x16x32_bf16 v[164:167], a[20:23], v[28:31], v[164:167]
v_mfma_f32_16x16x32_bf16 v[180:183], a[24:27], v[28:31], v[180:183]
v_mfma_f32_16x16x32_bf16 v[196:199], a[28:31], v[28:31], v[196:199]
buffer_load_dwordx4 v[28:31], v129, s[36:39], s74 offen offset:2048 sc1
s_waitcnt vmcnt(11)
v_mfma_f32_16x16x32_bf16 v[152:155], a[16:19], v[32:35], v[152:155]
v_mfma_f32_16x16x32_bf16 v[168:171], a[20:23], v[32:35], v[168:171]
v_mfma_f32_16x16x32_bf16 v[184:187], a[24:27], v[32:35], v[184:187]
v_mfma_f32_16x16x32_bf16 v[200:203], a[28:31], v[32:35], v[200:203]
buffer_load_dwordx4 v[32:35], v130, s[36:39], s74 offen offset:2048 sc1
s_waitcnt vmcnt(11)
v_mfma_f32_16x16x32_bf16 v[156:159], a[16:19], v[36:39], v[156:159]
v_mfma_f32_16x16x32_bf16 v[172:175], a[20:23], v[36:39], v[172:175]
v_mfma_f32_16x16x32_bf16 v[188:191], a[24:27], v[36:39], v[188:191]
v_mfma_f32_16x16x32_bf16 v[204:207], a[28:31], v[36:39], v[204:207]
buffer_load_dwordx4 v[36:39], v131, s[36:39], s74 offen offset:2048 sc1
v_add_u32 v124, 0xffff0000, v124
v_add_u32 v125, 0xffff0000, v125
v_add_u32 v126, 0xffff0000, v126
v_add_u32 v127, 0xffff0000, v127
ds_read_b64_tr_b16 a[64:65], v124 offset:32768
ds_read_b64_tr_b16 a[66:67], v124 offset:34816
ds_read_b64_tr_b16 a[68:69], v125 offset:32768
ds_read_b64_tr_b16 a[70:71], v125 offset:34816
ds_read_b64_tr_b16 a[72:73], v126 offset:32768
ds_read_b64_tr_b16 a[74:75], v126 offset:34816
ds_read_b64_tr_b16 a[76:77], v127 offset:32768
ds_read_b64_tr_b16 a[78:79], v127 offset:34816
s_waitcnt lgkmcnt(15)
s_waitcnt vmcnt(11)
v_mfma_f32_16x16x32_bf16 v[144:147], a[32:35], v[40:43], v[144:147]
v_mfma_f32_16x16x32_bf16 v[160:163], a[36:39], v[40:43], v[160:163]
v_mfma_f32_16x16x32_bf16 v[176:179], a[40:43], v[40:43], v[176:179]
v_mfma_f32_16x16x32_bf16 v[192:195], a[44:47], v[40:43], v[192:195]
buffer_load_dwordx4 v[40:43], v128, s[36:39], s74 offen offset:3072 sc1
s_waitcnt vmcnt(11)
v_mfma_f32_16x16x32_bf16 v[148:151], a[32:35], v[44:47], v[148:151]
v_mfma_f32_16x16x32_bf16 v[164:167], a[36:39], v[44:47], v[164:167]
v_mfma_f32_16x16x32_bf16 v[180:183], a[40:43], v[44:47], v[180:183]
v_mfma_f32_16x16x32_bf16 v[196:199], a[44:47], v[44:47], v[196:199]
buffer_load_dwordx4 v[44:47], v129, s[36:39], s74 offen offset:3072 sc1
s_waitcnt vmcnt(11)
v_mfma_f32_16x16x32_bf16 v[152:155], a[32:35], v[48:51], v[152:155]
v_mfma_f32_16x16x32_bf16 v[168:171], a[36:39], v[48:51], v[168:171]
v_mfma_f32_16x16x32_bf16 v[184:187], a[40:43], v[48:51], v[184:187]
v_mfma_f32_16x16x32_bf16 v[200:203], a[44:47], v[48:51], v[200:203]
buffer_load_dwordx4 v[48:51], v130, s[36:39], s74 offen offset:3072 sc1
s_waitcnt vmcnt(11)
v_mfma_f32_16x16x32_bf16 v[156:159], a[32:35], v[52:55], v[156:159]
v_mfma_f32_16x16x32_bf16 v[172:175], a[36:39], v[52:55], v[172:175]
v_mfma_f32_16x16x32_bf16 v[188:191], a[40:43], v[52:55], v[188:191]
v_mfma_f32_16x16x32_bf16 v[204:207], a[44:47], v[52:55], v[204:207]
buffer_load_dwordx4 v[52:55], v131, s[36:39], s74 offen offset:3072 sc1
ds_read_b64_tr_b16 a[80:81], v124 offset:49152
ds_read_b64_tr_b16 a[82:83], v124 offset:51200
ds_read_b64_tr_b16 a[84:85], v125 offset:49152
ds_read_b64_tr_b16 a[86:87], v125 offset:51200
ds_read_b64_tr_b16 a[88:89], v126 offset:49152
ds_read_b64_tr_b16 a[90:91], v126 offset:51200
ds_read_b64_tr_b16 a[92:93], v127 offset:49152
ds_read_b64_tr_b16 a[94:95], v127 offset:51200
s_waitcnt lgkmcnt(15)
s_waitcnt vmcnt(11)
v_mfma_f32_16x16x32_bf16 v[144:147], a[48:51], v[56:59], v[144:147]
v_mfma_f32_16x16x32_bf16 v[160:163], a[52:55], v[56:59], v[160:163]
v_mfma_f32_16x16x32_bf16 v[176:179], a[56:59], v[56:59], v[176:179]
v_mfma_f32_16x16x32_bf16 v[192:195], a[60:63], v[56:59], v[192:195]
s_waitcnt vmcnt(10)
v_mfma_f32_16x16x32_bf16 v[148:151], a[48:51], v[60:63], v[148:151]
v_mfma_f32_16x16x32_bf16 v[164:167], a[52:55], v[60:63], v[164:167]
v_mfma_f32_16x16x32_bf16 v[180:183], a[56:59], v[60:63], v[180:183]
v_mfma_f32_16x16x32_bf16 v[196:199], a[60:63], v[60:63], v[196:199]
s_waitcnt vmcnt(9)
v_mfma_f32_16x16x32_bf16 v[152:155], a[48:51], v[64:67], v[152:155]
v_mfma_f32_16x16x32_bf16 v[168:171], a[52:55], v[64:67], v[168:171]
v_mfma_f32_16x16x32_bf16 v[184:187], a[56:59], v[64:67], v[184:187]
v_mfma_f32_16x16x32_bf16 v[200:203], a[60:63], v[64:67], v[200:203]
s_waitcnt vmcnt(8)
v_mfma_f32_16x16x32_bf16 v[156:159], a[48:51], v[68:71], v[156:159]
v_mfma_f32_16x16x32_bf16 v[172:175], a[52:55], v[68:71], v[172:175]
v_mfma_f32_16x16x32_bf16 v[188:191], a[56:59], v[68:71], v[188:191]
v_mfma_f32_16x16x32_bf16 v[204:207], a[60:63], v[68:71], v[204:207]
s_waitcnt lgkmcnt(8)
s_waitcnt vmcnt(7)
v_mfma_f32_16x16x32_bf16 v[144:147], a[64:67], v[24:27], v[144:147]
v_mfma_f32_16x16x32_bf16 v[160:163], a[68:71], v[24:27], v[160:163]
v_mfma_f32_16x16x32_bf16 v[176:179], a[72:75], v[24:27], v[176:179]
v_mfma_f32_16x16x32_bf16 v[192:195], a[76:79], v[24:27], v[192:195]
s_waitcnt vmcnt(6)
v_mfma_f32_16x16x32_bf16 v[148:151], a[64:67], v[28:31], v[148:151]
v_mfma_f32_16x16x32_bf16 v[164:167], a[68:71], v[28:31], v[164:167]
v_mfma_f32_16x16x32_bf16 v[180:183], a[72:75], v[28:31], v[180:183]
v_mfma_f32_16x16x32_bf16 v[196:199], a[76:79], v[28:31], v[196:199]
s_waitcnt vmcnt(5)
v_mfma_f32_16x16x32_bf16 v[152:155], a[64:67], v[32:35], v[152:155]
v_mfma_f32_16x16x32_bf16 v[168:171], a[68:71], v[32:35], v[168:171]
v_mfma_f32_16x16x32_bf16 v[184:187], a[72:75], v[32:35], v[184:187]
v_mfma_f32_16x16x32_bf16 v[200:203], a[76:79], v[32:35], v[200:203]
s_waitcnt vmcnt(4)
v_mfma_f32_16x16x32_bf16 v[156:159], a[64:67], v[36:39], v[156:159]
v_mfma_f32_16x16x32_bf16 v[172:175], a[68:71], v[36:39], v[172:175]
v_mfma_f32_16x16x32_bf16 v[188:191], a[72:75], v[36:39], v[188:191]
v_mfma_f32_16x16x32_bf16 v[204:207], a[76:79], v[36:39], v[204:207]
s_waitcnt lgkmcnt(0)
s_waitcnt vmcnt(3)
v_mfma_f32_16x16x32_bf16 v[144:147], a[80:83], v[40:43], v[144:147]
v_mfma_f32_16x16x32_bf16 v[160:163], a[84:87], v[40:43], v[160:163]
v_mfma_f32_16x16x32_bf16 v[176:179], a[88:91], v[40:43], v[176:179]
v_mfma_f32_16x16x32_bf16 v[192:195], a[92:95], v[40:43], v[192:195]
s_waitcnt vmcnt(2)
v_mfma_f32_16x16x32_bf16 v[148:151], a[80:83], v[44:47], v[148:151]
v_mfma_f32_16x16x32_bf16 v[164:167], a[84:87], v[44:47], v[164:167]
v_mfma_f32_16x16x32_bf16 v[180:183], a[88:91], v[44:47], v[180:183]
v_mfma_f32_16x16x32_bf16 v[196:199], a[92:95], v[44:47], v[196:199]
s_waitcnt vmcnt(1)
v_mfma_f32_16x16x32_bf16 v[152:155], a[80:83], v[48:51], v[152:155]
v_mfma_f32_16x16x32_bf16 v[168:171], a[84:87], v[48:51], v[168:171]
v_mfma_f32_16x16x32_bf16 v[184:187], a[88:91], v[48:51], v[184:187]
v_mfma_f32_16x16x32_bf16 v[200:203], a[92:95], v[48:51], v[200:203]
s_waitcnt vmcnt(0)
v_mfma_f32_16x16x32_bf16 v[156:159], a[80:83], v[52:55], v[156:159]
v_mfma_f32_16x16x32_bf16 v[172:175], a[84:87], v[52:55], v[172:175]
v_mfma_f32_16x16x32_bf16 v[188:191], a[88:91], v[52:55], v[188:191]
v_mfma_f32_16x16x32_bf16 v[204:207], a[92:95], v[52:55], v[204:207]
v_lshrrev_b32 v240, 4, v1
v_and_b32 v241, 15, v1
v_and_b32 v243, 2, v240
v_xor_b32 v243, v243, v241
v_lshlrev_b32 v243, 4, v243
v_lshl_add_u32 v243, v240, 8, v243
v_add_u32 v120, s75, v243
v_xor_b32 v121, 64, v120
v_xor_b32 v122, 128, v120
v_xor_b32 v123, 192, v120
v_lshrrev_b32 v243, 3, v1
v_and_b32 v244, 7, v1
v_lshlrev_b32 v245, 1, v244
v_xor_b32 v245, v245, v243
v_lshlrev_b32 v245, 4, v245
v_lshl_add_u32 v245, v244, 9, v245
s_lshl_b32 s54, s3, 14
v_add_u32 v124, s54, v245
v_xor_b32 v125, 128, v124
v_mul_u32_u24 v128, 1152, v243
v_lshl_add_u32 v128, v244, 4, v128
s_waitcnt lgkmcnt(0)
ds_write_b128 v120, v[144:147] offset:0
ds_write_b128 v121, v[160:163] offset:1024
ds_write_b128 v122, v[176:179] offset:2048
ds_write_b128 v123, v[192:195] offset:3072
ds_write_b128 v120, v[148:151] offset:16384
ds_write_b128 v121, v[164:167] offset:17408
ds_write_b128 v122, v[180:183] offset:18432
ds_write_b128 v123, v[196:199] offset:19456
ds_write_b128 v120, v[152:155] offset:32768
ds_write_b128 v121, v[168:171] offset:33792
ds_write_b128 v122, v[184:187] offset:34816
ds_write_b128 v123, v[200:203] offset:35840
ds_write_b128 v120, v[156:159] offset:49152
ds_write_b128 v121, v[172:175] offset:50176
ds_write_b128 v122, v[188:191] offset:51200
ds_write_b128 v123, v[204:207] offset:52224
s_mov_b32 s44, s14
s_mov_b32 s45, s15
s_mov_b32 s46, 1769472
s_mov_b32 s47, 0x20000
s_mul_i32 s58, s68, 192
s_lshl_b32 s59, s70, 6
s_add_u32 s58, s58, s59
s_lshl_b32 s59, s3, 4
s_add_u32 s58, s58, s59
s_mul_i32 s58, s58, 1152
s_lshl_b32 s59, s71, 7
s_add_u32 s58, s58, s59
s_add_u32 s59, s58, 9216
s_waitcnt lgkmcnt(0)
s_barrier
ds_read_b128 v[8:11], v124 offset:0
ds_read_b128 v[12:15], v124 offset:4096
ds_read_b128 v[16:19], v124 offset:8192
ds_read_b128 v[20:23], v124 offset:12288
ds_read_b128 v[24:27], v124 offset:256
ds_read_b128 v[28:31], v124 offset:4352
ds_read_b128 v[32:35], v124 offset:8448
ds_read_b128 v[36:39], v124 offset:12544
ds_read_b128 v[40:43], v125 offset:0
ds_read_b128 v[44:47], v125 offset:4096
ds_read_b128 v[48:51], v125 offset:8192
ds_read_b128 v[52:55], v125 offset:12288
ds_read_b128 v[56:59], v125 offset:256
ds_read_b128 v[60:63], v125 offset:4352
ds_read_b128 v[64:67], v125 offset:8448
ds_read_b128 v[68:71], v125 offset:12544
s_waitcnt lgkmcnt(12)
v_pk_add_f32 v[8:9], v[8:9], v[12:13]
v_pk_add_f32 v[16:17], v[16:17], v[20:21]
v_pk_add_f32 v[10:11], v[10:11], v[14:15]
v_pk_add_f32 v[18:19], v[18:19], v[22:23]
v_pk_add_f32 v[8:9], v[8:9], v[16:17]
v_pk_add_f32 v[10:11], v[10:11], v[18:19]
s_waitcnt lgkmcnt(8)
v_pk_add_f32 v[24:25], v[24:25], v[28:29]
v_pk_add_f32 v[32:33], v[32:33], v[36:37]
v_pk_add_f32 v[26:27], v[26:27], v[30:31]
v_pk_add_f32 v[34:35], v[34:35], v[38:39]
v_pk_add_f32 v[24:25], v[24:25], v[32:33]
v_pk_add_f32 v[26:27], v[26:27], v[34:35]
v_cvt_pk_bf16_f32 v12, v8, v9
v_cvt_pk_bf16_f32 v13, v10, v11
v_cvt_pk_bf16_f32 v14, v24, v25
v_cvt_pk_bf16_f32 v15, v26, v27
buffer_store_dwordx4 v[12:15], v128, s[44:47], s58 offen
s_waitcnt lgkmcnt(4)
v_pk_add_f32 v[40:41], v[40:41], v[44:45]
v_pk_add_f32 v[48:49], v[48:49], v[52:53]
v_pk_add_f32 v[42:43], v[42:43], v[46:47]
v_pk_add_f32 v[50:51], v[50:51], v[54:55]
v_pk_add_f32 v[40:41], v[40:41], v[48:49]
v_pk_add_f32 v[42:43], v[42:43], v[50:51]
s_waitcnt lgkmcnt(0)
v_pk_add_f32 v[56:57], v[56:57], v[60:61]
v_pk_add_f32 v[64:65], v[64:65], v[68:69]
v_pk_add_f32 v[58:59], v[58:59], v[62:63]
v_pk_add_f32 v[66:67], v[66:67], v[70:71]
v_pk_add_f32 v[56:57], v[56:57], v[64:65]
v_pk_add_f32 v[58:59], v[58:59], v[66:67]
v_cvt_pk_bf16_f32 v44, v40, v41
v_cvt_pk_bf16_f32 v45, v42, v43
v_cvt_pk_bf16_f32 v46, v56, v57
v_cvt_pk_bf16_f32 v47, v58, v59
buffer_store_dwordx4 v[44:47], v128, s[44:47], s59 offen
s_waitcnt vmcnt(0)
s_endpgm
L_signal_only:
s_waitcnt vmcnt(0)
s_endpgm
L_fallback:
s_waitcnt vmcnt(0)
s_barrier
s_mov_b32 s65, 1
v_mov_b32 v16, 0xff800000
v_mov_b32 v17, 0xff800000
v_mov_b32 v18, 0xff800000
v_mov_b32 v19, 0xff800000
v_mov_b32 v20, 0xff800000
v_mov_b32 v21, 0xff800000
s_mov_b32 s64, 0
L_fb_loop:
s_lshl_b32 m0, s3, 12
s_lshl_b32 s60, s64, 13
buffer_load_dwordx4 v2, s[20:23], s60 offen offset:0 lds
buffer_load_dwordx4 v3, s[20:23], s60 offen offset:1024 lds
buffer_load_dwordx4 v2, s[20:23], s60 offen offset:2048 lds
buffer_load_dwordx4 v3, s[20:23], s60 offen offset:3072 lds
s_waitcnt vmcnt(0)
s_barrier
ds_read_b128 a[192:195], v4 offset:0
ds_read_b128 a[196:199], v5 offset:0
ds_read_b128 a[200:203], v6 offset:0
ds_read_b128 a[204:207], v7 offset:0
s_waitcnt lgkmcnt(0)
v_mfma_f32_16x16x32_bf16 v[24:27], a[192:195], a[96:99], 0
v_mfma_f32_16x16x32_bf16 v[28:31], a[192:195], a[112:115], 0
v_mfma_f32_16x16x32_bf16 v[32:35], a[192:195], a[128:131], 0
v_mfma_f32_16x16x32_bf16 v[36:39], a[192:195], a[144:147], 0
v_mfma_f32_16x16x32_bf16 v[40:43], a[192:195], a[160:163], 0
v_mfma_f32_16x16x32_bf16 v[44:47], a[192:195], a[176:179], 0
v_mfma_f32_16x16x32_bf16 v[24:27], a[196:199], a[100:103], v[24:27]
v_mfma_f32_16x16x32_bf16 v[28:31], a[196:199], a[116:119], v[28:31]
v_mfma_f32_16x16x32_bf16 v[32:35], a[196:199], a[132:135], v[32:35]
v_mfma_f32_16x16x32_bf16 v[36:39], a[196:199], a[148:151], v[36:39]
v_mfma_f32_16x16x32_bf16 v[40:43], a[196:199], a[164:167], v[40:43]
v_mfma_f32_16x16x32_bf16 v[44:47], a[196:199], a[180:183], v[44:47]
v_mfma_f32_16x16x32_bf16 v[24:27], a[200:203], a[104:107], v[24:27]
v_mfma_f32_16x16x32_bf16 v[28:31], a[200:203], a[120:123], v[28:31]
v_mfma_f32_16x16x32_bf16 v[32:35], a[200:203], a[136:139], v[32:35]
v_mfma_f32_16x16x32_bf16 v[36:39], a[200:203], a[152:155], v[36:39]
v_mfma_f32_16x16x32_bf16 v[40:43], a[200:203], a[168:171], v[40:43]
v_mfma_f32_16x16x32_bf16 v[44:47], a[200:203], a[184:187], v[44:47]
v_mfma_f32_16x16x32_bf16 v[24:27], a[204:207], a[108:111], v[24:27]
v_mfma_f32_16x16x32_bf16 v[28:31], a[204:207], a[124:127], v[28:31]
v_mfma_f32_16x16x32_bf16 v[32:35], a[204:207], a[140:143], v[32:35]
v_mfma_f32_16x16x32_bf16 v[36:39], a[204:207], a[156:159], v[36:39]
v_mfma_f32_16x16x32_bf16 v[40:43], a[204:207], a[172:175], v[40:43]
v_mfma_f32_16x16x32_bf16 v[44:47], a[204:207], a[188:191], v[44:47]
ds_read_b128 a[192:195], v4 offset:4096
ds_read_b128 a[196:199], v5 offset:4096
ds_read_b128 a[200:203], v6 offset:4096
ds_read_b128 a[204:207], v7 offset:4096
s_waitcnt lgkmcnt(0)
v_mfma_f32_16x16x32_bf16 v[48:51], a[192:195], a[96:99], 0
v_mfma_f32_16x16x32_bf16 v[52:55], a[192:195], a[112:115], 0
v_mfma_f32_16x16x32_bf16 v[56:59], a[192:195], a[128:131], 0
v_mfma_f32_16x16x32_bf16 v[60:63], a[192:195], a[144:147], 0
v_mfma_f32_16x16x32_bf16 v[64:67], a[192:195], a[160:163], 0
v_mfma_f32_16x16x32_bf16 v[68:71], a[192:195], a[176:179], 0
v_mfma_f32_16x16x32_bf16 v[48:51], a[196:199], a[100:103], v[48:51]
v_mfma_f32_16x16x32_bf16 v[52:55], a[196:199], a[116:119], v[52:55]
v_mfma_f32_16x16x32_bf16 v[56:59], a[196:199], a[132:135], v[56:59]
v_mfma_f32_16x16x32_bf16 v[60:63], a[196:199], a[148:151], v[60:63]
v_mfma_f32_16x16x32_bf16 v[64:67], a[196:199], a[164:167], v[64:67]
v_mfma_f32_16x16x32_bf16 v[68:71], a[196:199], a[180:183], v[68:71]
v_mfma_f32_16x16x32_bf16 v[48:51], a[200:203], a[104:107], v[48:51]
v_mfma_f32_16x16x32_bf16 v[52:55], a[200:203], a[120:123], v[52:55]
v_mfma_f32_16x16x32_bf16 v[56:59], a[200:203], a[136:139], v[56:59]
v_mfma_f32_16x16x32_bf16 v[60:63], a[200:203], a[152:155], v[60:63]
v_mfma_f32_16x16x32_bf16 v[64:67], a[200:203], a[168:171], v[64:67]
v_mfma_f32_16x16x32_bf16 v[68:71], a[200:203], a[184:187], v[68:71]
v_mfma_f32_16x16x32_bf16 v[48:51], a[204:207], a[108:111], v[48:51]
v_mfma_f32_16x16x32_bf16 v[52:55], a[204:207], a[124:127], v[52:55]
v_mfma_f32_16x16x32_bf16 v[56:59], a[204:207], a[140:143], v[56:59]
v_mfma_f32_16x16x32_bf16 v[60:63], a[204:207], a[156:159], v[60:63]
v_mfma_f32_16x16x32_bf16 v[64:67], a[204:207], a[172:175], v[64:67]
v_mfma_f32_16x16x32_bf16 v[68:71], a[204:207], a[188:191], v[68:71]
s_nop 7
v_max3_f32 v16, v24, v25, v16
v_max3_f32 v16, v26, v27, v16
v_max3_f32 v17, v28, v29, v17
v_max3_f32 v17, v30, v31, v17
v_max3_f32 v18, v32, v33, v18
v_max3_f32 v18, v34, v35, v18
v_max3_f32 v19, v36, v37, v19
v_max3_f32 v19, v38, v39, v19
v_max3_f32 v20, v40, v41, v20
v_max3_f32 v20, v42, v43, v20
v_max3_f32 v21, v44, v45, v21
v_max3_f32 v21, v46, v47, v21
v_max3_f32 v16, v48, v49, v16
v_max3_f32 v16, v50, v51, v16
v_max3_f32 v17, v52, v53, v17
v_max3_f32 v17, v54, v55, v17
v_max3_f32 v18, v56, v57, v18
v_max3_f32 v18, v58, v59, v18
v_max3_f32 v19, v60, v61, v19
v_max3_f32 v19, v62, v63, v19
v_max3_f32 v20, v64, v65, v20
v_max3_f32 v20, v66, v67, v20
v_max3_f32 v21, v68, v69, v21
v_max3_f32 v21, v70, v71, v21
s_barrier
s_add_u32 s64, s64, 1
s_cmp_lt_u32 s64, 32
s_cbranch_scc1 L_fb_loop
v_mov_b32 v240, v16
v_mov_b32 v241, v17
v_mov_b32 v242, v18
v_mov_b32 v243, v19
v_mov_b32 v244, v20
v_mov_b32 v245, v21
s_nop 1
v_permlane32_swap_b32 v16, v240
v_permlane32_swap_b32 v17, v241
v_permlane32_swap_b32 v18, v242
v_permlane32_swap_b32 v19, v243
v_permlane32_swap_b32 v20, v244
v_permlane32_swap_b32 v21, v245
s_nop 1
v_max_f32 v16, v16, v240
v_max_f32 v17, v17, v241
v_max_f32 v18, v18, v242
v_max_f32 v19, v19, v243
v_max_f32 v20, v20, v244
v_max_f32 v21, v21, v245
v_mov_b32 v240, v16
v_mov_b32 v241, v17
v_mov_b32 v242, v18
v_mov_b32 v243, v19
v_mov_b32 v244, v20
v_mov_b32 v245, v21
s_nop 1
v_permlane16_swap_b32 v16, v240
v_permlane16_swap_b32 v17, v241
v_permlane16_swap_b32 v18, v242
v_permlane16_swap_b32 v19, v243
v_permlane16_swap_b32 v20, v244
v_permlane16_swap_b32 v21, v245
s_nop 1
v_max_f32 v16, v16, v240
v_max_f32 v17, v17, v241
v_max_f32 v18, v18, v242
v_max_f32 v19, v19, v243
v_max_f32 v20, v20, v244
v_max_f32 v21, v21, v245
v_lshlrev_b32 v246, 2, v1
s_mul_i32 s54, s3, 1536
s_xor_b32 s55, s3, 1
s_mul_i32 s55, s55, 1536
v_add_u32 v246, 131072, v246
v_add_u32 v247, s55, v246
v_add_u32 v246, s54, v246
ds_write_b32 v246, v16 offset:0
ds_write_b32 v246, v17 offset:256
ds_write_b32 v246, v18 offset:512
ds_write_b32 v246, v19 offset:768
ds_write_b32 v246, v20 offset:1024
ds_write_b32 v246, v21 offset:1280
s_waitcnt lgkmcnt(0)
s_barrier
ds_read_b32 v240, v247 offset:768
ds_read_b32 v241, v247 offset:1024
ds_read_b32 v242, v247 offset:1280
ds_read_b32 v243, v247 offset:0
ds_read_b32 v244, v247 offset:256
ds_read_b32 v245, v247 offset:512
s_waitcnt lgkmcnt(0)
v_max_f32 v240, v240, v16
v_sub_f32 v120, 0, v240
v_sub_f32 v121, 0, v240
v_sub_f32 v122, 0, v240
v_sub_f32 v123, 0, v240
v_max_f32 v241, v241, v17
v_sub_f32 v124, 0, v241
v_sub_f32 v125, 0, v241
v_sub_f32 v126, 0, v241
v_sub_f32 v127, 0, v241
v_max_f32 v242, v242, v18
v_sub_f32 v128, 0, v242
v_sub_f32 v129, 0, v242
v_sub_f32 v130, 0, v242
v_sub_f32 v131, 0, v242
v_max_f32 v243, v243, v19
v_sub_f32 v132, 0, v243
v_sub_f32 v133, 0, v243
v_sub_f32 v134, 0, v243
v_sub_f32 v135, 0, v243
v_max_f32 v244, v244, v20
v_sub_f32 v136, 0, v244
v_sub_f32 v137, 0, v244
v_sub_f32 v138, 0, v244
v_sub_f32 v139, 0, v244
v_max_f32 v245, v245, v21
v_sub_f32 v140, 0, v245
v_sub_f32 v141, 0, v245
v_sub_f32 v142, 0, v245
v_sub_f32 v143, 0, v245
s_lshl_b32 s71, s3, 12
s_add_u32 m0, s71, 0
s_add_u32 s55, s79, 0
s_and_b32 s55, s55, 31
s_lshl_b32 s55, s55, 13
buffer_load_dwordx4 v2, s[20:23], s55 offen offset:0 nt lds
buffer_load_dwordx4 v3, s[20:23], s55 offen offset:1024 nt lds
buffer_load_dwordx4 v2, s[20:23], s55 offen offset:2048 nt lds
buffer_load_dwordx4 v3, s[20:23], s55 offen offset:3072 nt lds
s_add_u32 m0, s71, 32768
s_add_u32 s55, s79, 1
s_and_b32 s55, s55, 31
s_lshl_b32 s55, s55, 13
buffer_load_dwordx4 v2, s[20:23], s55 offen offset:0 nt lds
buffer_load_dwordx4 v3, s[20:23], s55 offen offset:1024 nt lds
buffer_load_dwordx4 v2, s[20:23], s55 offen offset:2048 nt lds
buffer_load_dwordx4 v3, s[20:23], s55 offen offset:3072 nt lds
s_add_u32 m0, s71, 49152
s_add_u32 s55, s79, 0
s_and_b32 s55, s55, 31
s_lshl_b32 s55, s55, 13
buffer_load_dwordx4 v2, s[24:27], s55 offen offset:0 nt lds
buffer_load_dwordx4 v3, s[24:27], s55 offen offset:1024 nt lds
buffer_load_dwordx4 v2, s[24:27], s55 offen offset:2048 nt lds
buffer_load_dwordx4 v3, s[24:27], s55 offen offset:3072 nt lds
s_add_u32 m0, s71, 65536
s_add_u32 s55, s79, 2
s_and_b32 s55, s55, 31
s_lshl_b32 s55, s55, 13
buffer_load_dwordx4 v2, s[20:23], s55 offen offset:0 nt lds
buffer_load_dwordx4 v3, s[20:23], s55 offen offset:1024 nt lds
buffer_load_dwordx4 v2, s[20:23], s55 offen offset:2048 nt lds
buffer_load_dwordx4 v3, s[20:23], s55 offen offset:3072 nt lds
s_add_u32 m0, s71, 81920
s_add_u32 s55, s79, 1
s_and_b32 s55, s55, 31
s_lshl_b32 s55, s55, 13
buffer_load_dwordx4 v2, s[24:27], s55 offen offset:0 nt lds
buffer_load_dwordx4 v3, s[24:27], s55 offen offset:1024 nt lds
buffer_load_dwordx4 v2, s[24:27], s55 offen offset:2048 nt lds
buffer_load_dwordx4 v3, s[24:27], s55 offen offset:3072 nt lds
s_add_u32 m0, s71, 98304
s_add_u32 s55, s79, 3
s_and_b32 s55, s55, 31
s_lshl_b32 s55, s55, 13
buffer_load_dwordx4 v2, s[20:23], s55 offen offset:0 nt lds
buffer_load_dwordx4 v3, s[20:23], s55 offen offset:1024 nt lds
v_mov_b32 v16, 0
v_mov_b32 v17, 0
v_mov_b32 v18, 0
v_mov_b32 v19, 0
v_mov_b32 v20, 0
v_mov_b32 v21, 0
s_lshl_b32 s54, s3, 12
s_add_u32 s54, s54, 150528
v_lshlrev_b32 v23, 2, v1
v_add_u32 v23, s54, v23
s_mov_b32 s64, 4
s_mov_b32 s60, 24576
s_mov_b32 s61, 16384
s_mov_b32 s73, 1073741824
s_add_u32 s60, s79, 3
s_and_b32 s60, s60, 31
s_lshl_b32 s60, s60, 13
s_add_u32 s61, s79, 2
s_and_b32 s61, s61, 31
s_lshl_b32 s61, s61, 13
s_lshl_b32 s62, s3, 12
s_add_u32 s62, s62, 98304
s_mov_b32 m0, s62
s_waitcnt vmcnt(0)
s_barrier
s_branch L_main
L_late:
s_cmp_lg_u32 s53, 2
s_cbranch_scc1 L_claim_ret
L_claim:
s_or_b32 s54, s3, s65
s_cmp_lg_u32 s54, 0
s_cbranch_scc1 L_claim_ret
s_mov_b32 s28, s16
s_mov_b32 s29, s17
s_mov_b32 s30, 256
s_mov_b32 s31, 0x20000
s_and_b32 s54, s2, 7
s_lshl_b32 s54, s54, 5
s_add_u32 s54, s54, 16
v_mov_b32 v22, 1
v_mov_b32 v240, s54
s_mov_b64 exec, 1
buffer_atomic_add v22, v240, s[28:31], 0 offen sc0 sc1
s_mov_b64 exec, -1
s_branch L_claim_ret
L_thr0:
s_waitcnt vmcnt(7)
s_branch L_thr0_ret
L_thr1:
s_waitcnt vmcnt(7)
s_branch L_thr1_ret
L_thr2:
s_waitcnt vmcnt(7)
s_branch L_thr2_ret
L_thr3:
s_waitcnt vmcnt(7)
s_branch L_thr3_ret
L_thr4:
s_waitcnt vmcnt(7)
s_branch L_thr4_ret
L_thr5:
s_waitcnt vmcnt(7)
s_branch L_thr5_ret
L_thr6:
s_waitcnt vmcnt(7)
s_branch L_thr6_ret
L_thr7:
s_waitcnt vmcnt(7)
s_branch L_thr7_ret
L_end:
s_endpgm
.section .rodata,"a"
.p2align 6
.amdhsa_kernel standalone__mha_block_cached__near_ridge_kernel
.amdhsa_next_free_vgpr 512
.amdhsa_next_free_sgpr 102
.amdhsa_accum_offset 256
.amdhsa_group_segment_fixed_size 0
.amdhsa_kernarg_size 64
.amdhsa_user_sgpr_count 2
.amdhsa_user_sgpr_kernarg_segment_ptr 1
.amdhsa_system_sgpr_workgroup_id_x 1
.end_amdhsa_kernel
```
